```python
import torch

def _softmax(x, axis=-1):
    return torch.softmax(x, dim=axis)
def _gelu(x):
    return torch.nn.functional.gelu(x, approximate="tanh")
def _silu(x):
    return torch.nn.functional.silu(x)
def _sigmoid(x):
    return torch.sigmoid(x)
def _layernorm(x, axis=-1, eps=1e-5):
    m = x.mean(dim=axis, keepdim=True)
    v = x.var(dim=axis, keepdim=True, unbiased=False)
    return (x - m) / torch.sqrt(v + eps)
def _scatter_add(tgt, idx, src, axis=0):
    return tgt.clone().index_add_(axis, idx, src)
def _segment_sum(src, seg, n):
    out = torch.zeros((n,) + src.shape[1:], dtype=src.dtype)
    return out.index_add_(0, seg, src)
def _pad(x, pw):
    flat = tuple(v for pair in reversed(pw) for v in pair)
    return torch.nn.functional.pad(x, flat)

kernel_name = 'recurrent_scan__grouped_kv_mqa__moe_arch_mod__prompt'

def setup_inputs():

    _w = (lambda a: (lambda t: t.to(torch.bfloat16) if t.is_floating_point() else t)(torch.as_tensor(a)))
    def _A_setup():
        B, S, D, H = 1, 2048, 1024, 32
        Dh = D // H
        return {
            "x": _w((lambda *s: torch.randn(*s, dtype=torch.bfloat16) * 0.05)(B, S, D)),
            "wq": _w((lambda *s: torch.randn(*s, dtype=torch.bfloat16) * 0.05)(D, H * Dh)),
            "wk": _w((lambda *s: torch.randn(*s, dtype=torch.bfloat16) * 0.05)(D, Dh)),
            "wv": _w((lambda *s: torch.randn(*s, dtype=torch.bfloat16) * 0.05)(D, Dh)),
            "wo": _w((lambda *s: torch.randn(*s, dtype=torch.bfloat16) * 0.05)(H * Dh, D)),
        }
    _A_in = _A_setup()

    def _B_setup():
        B, S, D, F, C = 1, 2048, 1024, 3584, 1
        return {
            "x": _w((lambda *s: torch.randn(*s, dtype=torch.bfloat16) * 0.05)(B, S, D)),
            "w_r": _w((lambda *s: torch.randn(*s, dtype=torch.bfloat16) * 0.05)(D)),
            "w_gate": _w((lambda *s: torch.randn(*s, dtype=torch.bfloat16) * 0.05)(D, F)),
            "w_up": _w((lambda *s: torch.randn(*s, dtype=torch.bfloat16) * 0.05)(D, F)),
            "w_down": _w((lambda *s: torch.randn(*s, dtype=torch.bfloat16) * 0.05)(F, D)),
        }
    _B_in = _B_setup()

    return {
        "A_x": _A_in["x"],
        "A_wq": _A_in["wq"],
        "A_wk": _A_in["wk"],
        "A_wv": _A_in["wv"],
        "A_wo": _A_in["wo"],
        "B_x": _B_in["x"],
        "B_w_r": _B_in["w_r"],
        "B_w_gate": _B_in["w_gate"],
        "B_w_up": _B_in["w_up"],
        "B_w_down": _B_in["w_down"],
    }

def reference(A_x, A_wq, A_wk, A_wv, A_wo, B_x, B_w_r, B_w_gate, B_w_up, B_w_down):
    def _A_ref(x, wq, wk, wv, wo):
        B, S, D = x.shape
        H = 32
        Dh = D // H
        q = (lambda x, *d: x.permute(*d))((x @ wq).reshape(B, S, H, Dh), 0, 2, 1, 3)
        k = x @ wk
        v = x @ wv
        scores = torch.einsum("bhqd,bkd->bhqk", q, k) * (Dh ** -0.5)
        p = _softmax(scores, axis=-1)
        o = torch.einsum("bhqk,bkd->bhqd", p, v)
        return (lambda x, *d: x.permute(*d))(o, 0, 2, 1, 3).reshape(B, S, H * Dh) @ wo

    def _B_ref(x, w_r, w_gate, w_up, w_down):
        B, S, D = x.shape
        C = 1
        r = x @ w_r
        idx = torch.argsort(-r, axis=-1)[:, :C]
        idx_e = (lambda x, n, axis: torch.repeat_interleave(x, n, dim=axis))(idx.reshape(B, C, 1), D, axis=2)
        x_sel = (lambda x, i, axis: torch.take_along_dim(x, i, dim=axis))(x, idx_e, axis=1)
        g = _silu(x_sel @ w_gate)
        u = x_sel @ w_up
        y = (g * u) @ w_down
        r_sel = _sigmoid((lambda x, i, axis: torch.take_along_dim(x, i, dim=axis))(r, idx, axis=1))
        y = y * r_sel.reshape(B, C, 1)
        b_off = (torch.arange(B) * S).reshape(B, 1)
        flat_idx = (idx + b_off).reshape(B * C)
        zero = (x * 0.0).reshape(B * S, D)
        upd = _scatter_add(zero, flat_idx, y.reshape(B * C, D), axis=0)
        return x + upd.reshape(B, S, D)

    x = A_x
    xn = _layernorm(x, axis=-1)
    s = _A_ref(xn, A_wq, A_wk, A_wv, A_wo)
    g = _silu(_B_ref(xn, B_w_r, B_w_gate, B_w_up, B_w_down))
    return x + s * g
```

```asm
; @launch grid=(256,1,1) block=(512,1,1) lds=163840
.amdgcn_target "amdgcn-amd-amdhsa--gfx950"
.text
.globl recurrent_scan__grouped_kv_mqa__moe_arch_mod__prompt_kernel
.p2align 8
.type recurrent_scan__grouped_kv_mqa__moe_arch_mod__prompt_kernel,@function
recurrent_scan__grouped_kv_mqa__moe_arch_mod__prompt_kernel:
    s_cmp_ge_u32 s2, 256
    s_cbranch_scc1 L_end
    s_load_dwordx4 s[16:19], s[0:1], 0
    v_lshrrev_b32 v5, 6, v0
    v_bfe_u32 v6, v0, 4, 2
    v_readfirstlane_b32 s3, v5
    v_and_b32 v7, 15, v0
    v_lshl_add_u32 v14, v5, 3, v6
    s_and_b32 s7, s2, 7
    s_bfe_u32 s6, s2, 0x20003
    s_lshr_b32 s5, s2, 5
    s_lshl2_add_u32 s4, s7, s6
    s_lshl1_add_u32 s8, s5, s7
    s_and_b32 s8, s8, 7
    s_lshl_b32 s95, s4, 17
    s_lshl_b32 s98, s3, 11
    v_xor_b32 v15, v14, v0
    v_and_b32 v15, 15, v15
    v_lshl_add_u32 v15, v15, 4, s95
    v_lshl_add_u32 v8, v14, 11, v15
    v_xor_b32 v9, 0x2040, v8
    s_lshl_b32 s26, s8, 8
    s_mov_b32 s46, 4194304
    s_mov_b32 s47, 0x00020000
    s_waitcnt lgkmcnt(0)
    s_mov_b32 s44, s16
    s_and_b32 s45, s17, 0xffff
    s_load_dwordx4 s[20:23], s[0:1], 16
    s_load_dwordx2 s[24:25], s[0:1], 32
    s_load_dwordx4 s[28:31], s[0:1], 48
    s_load_dwordx8 s[32:39], s[0:1], 64
    s_load_dwordx2 s[40:41], s[0:1], 96
    s_add_u32 m0, s98, 0
    s_nop 0
    buffer_load_dwordx4 v8, s[44:47], s26 offen lds
    s_add_u32 m0, s98, 1024
    s_add_u32 s0, s26, 256
    buffer_load_dwordx4 v9, s[44:47], s26 offen lds
    v_lshlrev_b32 v15, 2, v6
    v_xor_b32 v15, v15, v7
    v_lshlrev_b32 v15, 4, v15
    v_lshl_add_u32 v121, v14, 11, v15
    v_add_u32 v125, 8192, v121
    s_lshl_b32 s10, s5, 8
    s_lshl_b32 s27, s8, 18
    s_add_u32 s27, s27, s10
    s_mov_b32 s48, s18
    s_and_b32 s49, s19, 0xffff
    s_mov_b32 s50, 2097152
    s_mov_b32 s51, 0x00020000
    s_add_u32 m0, s98, 98304
    s_nop 0
    buffer_load_dwordx4 v121, s[48:51], s27 offen lds
    s_add_u32 m0, s98, 99328
    s_add_u32 s1, s27, 0x20000
    buffer_load_dwordx4 v125, s[48:51], s27 offen lds
    v_and_b32 v1, 63, v0
    v_lshlrev_b32 v2, 4, v1
    s_lshr_b32 s9, s2, 3
    s_lshr_b32 s90, s3, 2
    s_and_b32 s91, s3, 3
    v_bfe_u32 v14, v1, 2, 2
    v_lshrrev_b32 v15, 5, v1
    v_lshl_add_u32 v15, v15, 3, v14
    v_lshlrev_b32 v15, 8, v15
    v_xor_b32 v14, s91, v14
    v_lshl_add_u32 v15, v14, 6, v15
    v_bfe_u32 v14, v1, 4, 1
    v_lshl_add_u32 v15, v14, 5, v15
    v_and_b32 v14, 1, v1
    v_lshl_add_u32 v15, v14, 4, v15
    v_bfe_u32 v14, v1, 1, 1
    v_lshl_add_u32 v104, v14, 3, v15
    s_lshl_b32 s10, s90, 12
    s_add_u32 s10, s10, 0x10000
    v_add_u32 v5, s10, v104
    s_lshl_b32 s10, s90, 13
    s_xor_b32 s11, s10, 0x2000
    v_add_u32 v212, s11, v104
    v_add_u32 v104, s10, v104
    v_add_u32 v105, 65536, v104
    v_add_u32 v213, 65536, v212
    v_add_u32 v106, 131072, v104
    v_add_u32 v214, 131072, v212
    v_and_b32 v14, 31, v1
    v_lshrrev_b32 v15, 5, v1
    v_xor_b32 v15, v15, v7
    v_lshlrev_b32 v15, 4, v15
    v_lshl_add_u32 v14, v14, 8, v15
    s_lshl_b32 s10, s90, 13
    v_add_u32 v108, s10, v14
    s_lshl_b32 s10, s90, 6
    v_xor_b32 v108, s10, v108
    v_xor_b32 v109, 32, v108
    v_xor_b32 v110, 64, v108
    v_xor_b32 v111, 96, v108
    v_xor_b32 v112, 128, v108
    v_xor_b32 v113, 160, v108
    v_xor_b32 v114, 192, v108
    v_xor_b32 v115, 224, v108
    s_add_u32 m0, s98, 114688
    s_and_b32 s27, s1, 0x1fffff
    buffer_load_dwordx4 v121, s[48:51], s27 offen lds
    s_add_u32 m0, s98, 115712
    s_add_u32 s1, s27, 0x20000
    buffer_load_dwordx4 v125, s[48:51], s27 offen lds
    v_lshlrev_b32 v10, 6, v1
    v_lshlrev_b32 v11, 2, v1
    s_add_u32 s11, s8, s3
    s_and_b32 s11, s11, 7
    s_lshl_b32 s99, s11, 13
    s_and_b32 s13, s5, 3
    s_lshl4_add_u32 s99, s13, s99
    s_lshl_b32 s11, s11, 8
    s_cmp_lt_u32 s5, 4
    s_waitcnt lgkmcnt(0)
    s_cselect_b32 s52, s20, s22
    s_cselect_b32 s53, s21, s23
    s_and_b32 s53, s53, 0xffff
    s_mov_b32 s54, 65536
    s_mov_b32 s55, 0x00020000
    s_mov_b32 s60, s28
    s_and_b32 s61, s29, 0xffff
    s_mov_b32 s62, 2048
    s_mov_b32 s63, 0x00020000
    buffer_load_dword v12, v11, s[60:63], s11 offen
    s_cmp_eq_u32 s3, 7
    s_cbranch_scc1 L_rare_1
L_ret_3:
    s_mov_b32 s84, s40
    s_and_b32 s85, s41, 0xffff
    s_mov_b32 s86, 6291456
    s_mov_b32 s87, 0x00020000
    s_cmp_eq_u32 s3, 1
    s_cbranch_scc1 L_rare_4
L_ret_6:
    s_cmp_eq_u32 s3, 1
    s_cbranch_scc1 L_wd_8
    s_cmp_eq_u32 s3, 7
    s_cbranch_scc1 L_wd_9
    s_waitcnt vmcnt(3) lgkmcnt(0)
L_we_7:
    s_barrier
    ds_read_b64_tr_b16 v[24:25], v105 offset:32768
    ds_read_b64_tr_b16 v[26:27], v105 offset:33792
    ds_read_b128 v[40:43], v108 offset:0
    ds_read_b64_tr_b16 v[28:29], v105 offset:36864
    ds_read_b64_tr_b16 v[30:31], v105 offset:37888
    ds_read_b128 v[44:47], v109 offset:0
    ds_read_b64_tr_b16 v[32:33], v213 offset:32768
    ds_read_b64_tr_b16 v[34:35], v213 offset:33792
    ds_read_b128 v[48:51], v110 offset:0
    ds_read_b64_tr_b16 v[36:37], v213 offset:36864
    ds_read_b64_tr_b16 v[38:39], v213 offset:37888
    ds_read_b128 v[52:55], v111 offset:0
    s_add_u32 m0, s98, 131072
    s_nop 0
    buffer_load_dwordx4 v10, s[52:55], s99 offen lds
    s_mov_b32 s80, s38
    s_and_b32 s81, s39, 0xffff
    s_mov_b32 s82, 256
    s_mov_b32 s83, 0x00020000
    s_mov_b32 s56, s24
    s_and_b32 s57, s25, 0xffff
    s_mov_b32 s58, 2097152
    s_mov_b32 s59, 0x00020000
    s_mov_b32 s64, s30
    s_and_b32 s65, s31, 0xffff
    s_mov_b32 s66, 7340032
    s_mov_b32 s67, 0x00020000
    s_mov_b32 s68, s32
    s_and_b32 s69, s33, 0xffff
    s_mov_b32 s70, 7340032
    s_mov_b32 s71, 0x00020000
    s_mov_b32 s72, s34
    s_and_b32 s73, s35, 0xffff
    s_mov_b32 s74, 7340032
    s_mov_b32 s75, 0x00020000
    s_mov_b32 s76, s36
    s_and_b32 s77, s37, 0xffff
    s_mov_b32 s78, 4194304
    s_mov_b32 s79, 0x00020000
    s_lshl_b32 s10, s91, 12
    v_xor_b32 v14, v6, v7
    v_lshlrev_b32 v14, 4, v14
    v_lshl_add_u32 v14, v7, 8, v14
    v_add_u32 v14, s10, v14
    s_lshl_b32 s10, s90, 7
    v_xor_b32 v16, s10, v14
    v_xor_b32 v17, 64, v16
    v_add_u32 v18, 0x10000, v16
    v_add_u32 v19, 0x10000, v17
    v_add_u32 v20, 0x20000, v16
    v_add_u32 v21, 0x20000, v17
    v_bfe_u32 v14, v1, 2, 2
    v_lshl_add_u32 v14, v6, 3, v14
    v_lshlrev_b32 v14, 4, v14
    s_lshl_b32 s10, s90, 10
    s_add_u32 s10, s10, 131072
    v_add_u32 v14, s10, v14
    v_and_b32 v15, 1, v1
    v_lshl_add_u32 v15, v15, 3, v14
    v_and_b32 v123, 2, v1
    v_cmp_eq_u32 vcc, 0, v123
    v_add_u32 v123, 16448, v14
    v_add_u32 v14, 8264, v14
    v_cndmask_b32 v22, v123, v15, vcc
    v_cndmask_b32 v107, v14, v15, vcc
    v_and_b32 v14, 255, v0
    v_lshlrev_b32 v14, 5, v14
    s_lshl_b32 s10, s90, 3
    s_add_u32 s10, s10, 147520
    v_add_u32 v23, s10, v14
    v_and_b32 v14, 6, v1
    v_mov_b32 v15, 0x3f803f80
    v_cmp_eq_u32 vcc, 0, v14
    s_nop 1
    v_cndmask_b32 v116, 0, v15, vcc
    v_mov_b32 v117, v116
    v_cmp_eq_u32 vcc, 4, v14
    s_nop 1
    v_cndmask_b32 v118, 0, v15, vcc
    v_mov_b32 v119, v118
    v_and_b32 v14, 1, v1
    v_mov_b32 v120, 0x4444
    v_mov_b32 v15, 0xeeee
    v_cmp_eq_u32 vcc, 1, v14
    s_nop 1
    v_cndmask_b32 v120, v120, v15, vcc
    v_mov_b32 v232, 0
    v_mov_b32 v233, 0
    v_mov_b32 v234, 0
    v_mov_b32 v235, 0
    s_add_u32 s99, s99, 4096
    s_add_u32 m0, s98, 132096
    s_nop 0
    buffer_load_dwordx4 v10, s[52:55], s99 offen lds
    s_add_u32 m0, s98, 16384
    s_and_b32 s26, s0, 0x7ff
    buffer_load_dwordx4 v8, s[44:47], s26 offen lds
    s_add_u32 m0, s98, 17408
    s_add_u32 s0, s26, 256
    buffer_load_dwordx4 v9, s[44:47], s26 offen lds
    s_waitcnt vmcnt(4)
    v_and_b32 v14, 0xffff, v12
    v_or_b32 v14, 0x3f800000, v14
    v_mov_b32 v15, 0
    v_lshrrev_b32 v216, 16, v12
    v_or_b32 v216, 0x3f800000, v216
    v_mov_b32 v217, 0
    ds_write_b64 v23, v[14:15]
    ds_write_b64 v23, v[216:217] offset:16
    s_cmp_ge_u32 s5, 4
    s_cbranch_scc1 L_v_10
    v_and_b32 v15, 0x13, v1
    v_bfe_u32 v14, v1, 2, 1
    v_lshl_add_u32 v15, v14, 3, v15
    v_bfe_u32 v14, v1, 3, 1
    v_lshl_add_u32 v15, v14, 2, v15
    v_lshrrev_b32 v14, 5, v1
    v_lshlrev_b32 v14, 12, v14
    v_lshl_add_u32 v236, v15, 4, v14
    s_lshl_b32 s10, s5, 9
    s_branch L_st_11
L_v_10:
    v_lshlrev_b32 v237, 1, v1
    v_and_b32 v15, 7, v1
    v_lshrrev_b32 v14, 3, v1
    v_lshlrev_b32 v238, 8, v15
    v_lshl_add_u32 v238, v14, 4, v238
    v_and_b32 v123, 3, v14
    v_lshlrev_b32 v123, 9, v123
    v_lshrrev_b32 v14, 2, v14
    v_lshl_add_u32 v14, v14, 12, v123
    v_and_b32 v123, 3, v15
    v_bfe_u32 v15, v15, 2, 1
    v_lshl_add_u32 v123, v15, 3, v123
    v_lshl_add_u32 v236, v123, 4, v14
    s_and_b32 s10, s5, 1
    s_lshl_b32 s10, s10, 6
    s_and_b32 s11, s5, 2
    s_lshl_b32 s11, s11, 7
    s_add_u32 s10, s10, s11
    s_add_u32 s10, s10, 2048
L_st_11:
    s_lshl_b32 s11, s4, 13
    s_add_u32 s10, s10, s11
    v_add_u32 v236, s10, v236
    s_cmp_eq_u32 s3, 1
    s_cbranch_scc1 L_rare_12
L_ret_14:
    s_cmp_eq_u32 s3, 1
    s_cbranch_scc1 L_wd_16
    s_cmp_eq_u32 s3, 7
    s_cbranch_scc1 L_wd_17
    s_waitcnt vmcnt(5) lgkmcnt(0)
L_we_15:
    s_barrier
    v_mfma_f32_32x32x16_bf16 v[88:103], v[24:27], v[40:43], 0
    ds_read_b64_tr_b16 v[56:57], v105 offset:49152
    ds_read_b64_tr_b16 v[58:59], v105 offset:50176
    ds_read_b128 v[72:75], v112 offset:0
    s_add_u32 m0, s98, 98304
    s_and_b32 s27, s1, 0x1fffff
    buffer_load_dwordx4 v121, s[48:51], s27 offen lds
    ds_read_b64_tr_b16 v[60:61], v105 offset:53248
    ds_read_b64_tr_b16 v[62:63], v105 offset:54272
    ds_read_b128 v[76:79], v113 offset:0
    v_mfma_f32_32x32x16_bf16 v[88:103], v[28:31], v[44:47], v[88:103]
    s_add_u32 m0, s98, 99328
    s_add_u32 s1, s27, 0x20000
    buffer_load_dwordx4 v125, s[48:51], s27 offen lds
    ds_read_b64_tr_b16 v[64:65], v213 offset:49152
    ds_read_b64_tr_b16 v[66:67], v213 offset:50176
    ds_read_b128 v[80:83], v114 offset:0
    v_smfmac_f32_16x16x64_bf16 v[232:235], v[116:119], v[24:31], v120
    s_add_u32 m0, s98, 32768
    s_and_b32 s26, s0, 0x7ff
    buffer_load_dwordx4 v8, s[44:47], s26 offen lds
    v_mfma_f32_32x32x16_bf16 v[88:103], v[32:35], v[48:51], v[88:103]
    ds_read_b64_tr_b16 v[68:69], v213 offset:53248
    ds_read_b64_tr_b16 v[70:71], v213 offset:54272
    ds_read_b128 v[84:87], v115 offset:0
    s_add_u32 m0, s98, 33792
    s_add_u32 s0, s26, 256
    buffer_load_dwordx4 v9, s[44:47], s26 offen lds
    v_mfma_f32_32x32x16_bf16 v[88:103], v[36:39], v[52:55], v[88:103]
    v_lshrrev_b32 v123, 3, v1
    s_lshl_b32 s10, s3, 5
    v_add_u32 v123, s10, v123
    v_mul_u32_u24 v123, 7168, v123
    v_bfe_u32 v124, v1, 4, 1
    v_lshlrev_b32 v124, 1, v124
    v_xor_b32 v124, v124, v1
    v_and_b32 v124, 7, v124
    v_lshl_add_u32 v122, v124, 4, v123
    s_mul_i32 s10, s7, 28
    s_add_u32 s10, s10, s9
    s_lshr_b32 s92, s10, 2
    s_lshl_b32 s92, s92, 7
    s_mul_i32 s11, s6, 1835008
    s_add_u32 s92, s92, s11
    s_lshl_b32 s25, s10, 10
    s_add_u32 s25, s25, 278528
    s_cmp_lt_u32 s9, 28
    s_cselect_b32 s92, s92, 0
    s_cselect_b32 s97, 0, 0x40000000
    v_add_u32 v122, s97, v122
    v_xor_b32 v126, 64, v122
    s_mul_i32 s93, s7, 917504
    s_lshl_b32 s10, s9, 6
    s_add_u32 s93, s93, s10
    s_lshl_b32 s10, s3, 17
    s_cmp_eq_u32 s3, 7
    s_cselect_b32 s10, 0x40000000, s10
    v_lshrrev_b32 v123, 2, v1
    v_lshl_add_u32 v127, v123, 11, s10
    v_and_b32 v123, 3, v1
    v_lshl_add_u32 v127, v123, 4, v127
    s_lshl_b32 s94, s7, 13
    s_lshl_b32 s10, s9, 8
    s_add_u32 s94, s94, s10
    s_add_u32 s94, s94, 589824
    s_cmp_eq_u32 s3, 1
    s_cbranch_scc1 L_wd_19
    s_waitcnt vmcnt(4) lgkmcnt(0)
L_we_18:
    s_barrier
    v_mfma_f32_32x32x16_bf16 v[88:103], v[56:59], v[72:75], v[88:103]
    ds_read_b128 v[192:195], v16 offset:0
    ds_read_b128 v[196:199], v17 offset:0
    s_add_u32 m0, s98, 114688
    s_and_b32 s27, s1, 0x1fffff
    buffer_load_dwordx4 v121, s[48:51], s27 offen lds
    ds_read_b128 v[200:203], v16 offset:16384
    ds_read_b128 v[204:207], v17 offset:16384
    ds_read_b64_tr_b16 v[128:129], v22 offset:0
    ds_read_b64_tr_b16 v[130:131], v22 offset:64
    ds_read_b64_tr_b16 v[132:133], v22 offset:512
    ds_read_b64_tr_b16 v[134:135], v22 offset:576
    v_mfma_f32_32x32x16_bf16 v[88:103], v[60:63], v[76:79], v[88:103]
    s_add_u32 m0, s98, 115712
    s_add_u32 s1, s27, 0x20000
    buffer_load_dwordx4 v125, s[48:51], s27 offen lds
    ds_read_b64_tr_b16 v[136:137], v22 offset:2048
    ds_read_b64_tr_b16 v[138:139], v22 offset:2112
    ds_read_b64_tr_b16 v[140:141], v22 offset:2560
    ds_read_b64_tr_b16 v[142:143], v22 offset:2624
    ds_read_b64_tr_b16 v[144:145], v22 offset:4096
    ds_read_b64_tr_b16 v[146:147], v22 offset:4160
    ds_read_b64_tr_b16 v[148:149], v22 offset:4608
    ds_read_b64_tr_b16 v[150:151], v22 offset:4672
    ds_read_b64_tr_b16 v[152:153], v22 offset:6144
    ds_read_b64_tr_b16 v[154:155], v22 offset:6208
    ds_read_b64_tr_b16 v[156:157], v22 offset:6656
    ds_read_b64_tr_b16 v[158:159], v22 offset:6720
    v_smfmac_f32_16x16x64_bf16 v[232:235], v[116:119], v[56:63], v120
    s_add_u32 m0, s98, 49152
    s_and_b32 s26, s0, 0x7ff
    buffer_load_dwordx4 v8, s[44:47], s26 offen lds
    ds_read_b64_tr_b16 v[160:161], v107 offset:8192
    ds_read_b64_tr_b16 v[162:163], v107 offset:8256
    ds_read_b64_tr_b16 v[164:165], v107 offset:8704
    ds_read_b64_tr_b16 v[166:167], v107 offset:8768
    v_mfma_f32_32x32x16_bf16 v[88:103], v[64:67], v[80:83], v[88:103]
    ds_read_b64_tr_b16 v[168:169], v107 offset:10240
    ds_read_b64_tr_b16 v[170:171], v107 offset:10304
    ds_read_b64_tr_b16 v[172:173], v107 offset:10752
    ds_read_b64_tr_b16 v[174:175], v107 offset:10816
    s_add_u32 m0, s98, 50176
    s_add_u32 s0, s26, 256
    buffer_load_dwordx4 v9, s[44:47], s26 offen lds
    ds_read_b64_tr_b16 v[176:177], v107 offset:12288
    ds_read_b64_tr_b16 v[178:179], v107 offset:12352
    ds_read_b64_tr_b16 v[180:181], v107 offset:12800
    ds_read_b64_tr_b16 v[182:183], v107 offset:12864
    ds_read_b64_tr_b16 v[184:185], v107 offset:14336
    ds_read_b64_tr_b16 v[186:187], v107 offset:14400
    ds_read_b64_tr_b16 v[188:189], v107 offset:14848
    ds_read_b64_tr_b16 v[190:191], v107 offset:14912
    v_mfma_f32_32x32x16_bf16 v[88:103], v[68:71], v[84:87], v[88:103]
    s_lshl_b32 s54, s7, 7
    s_lshl_b32 s10, s9, 2
    s_add_u32 s54, s54, s10
    s_lshl_b32 s55, s7, 15
    s_add_u32 s55, s55, s98
    v_lshlrev_b32 v209, 2, v1
    v_and_b32 v211, 0x7c, v209
    s_waitcnt vmcnt(4) lgkmcnt(0)
    s_barrier
    v_mfma_f32_16x16x32_bf16 v[216:219], v[128:131], v[192:195], 0
    ds_read_b128 v[240:243], v16 offset:32768
    ds_read_b128 v[244:247], v17 offset:32768
    s_add_u32 m0, s98, 0
    s_and_b32 s27, s1, 0x1fffff
    buffer_load_dwordx4 v121, s[48:51], s27 offen lds
    v_mfma_f32_16x16x32_bf16 v[224:227], v[192:195], v[192:195], 0
    ds_read_b64_tr_b16 v[24:25], v105 offset:32768
    ds_read_b64_tr_b16 v[26:27], v105 offset:33792
    ds_read_b128 v[40:43], v108 offset:16384
    v_mfma_f32_16x16x32_bf16 v[216:219], v[132:135], v[196:199], v[216:219]
    s_add_u32 m0, s98, 1024
    s_add_u32 s1, s27, 0x20000
    buffer_load_dwordx4 v125, s[48:51], s27 offen lds
    ds_read_b64_tr_b16 v[28:29], v105 offset:36864
    ds_read_b64_tr_b16 v[30:31], v105 offset:37888
    ds_read_b128 v[44:47], v109 offset:16384
    v_mfma_f32_16x16x32_bf16 v[224:227], v[196:199], v[196:199], v[224:227]
    s_add_u32 m0, s98, 65536
    s_and_b32 s26, s0, 0x7ff
    buffer_load_dwordx4 v8, s[44:47], s26 offen lds
    v_mfma_f32_16x16x32_bf16 v[216:219], v[136:139], v[200:203], v[216:219]
    ds_read_b64_tr_b16 v[32:33], v213 offset:32768
    ds_read_b64_tr_b16 v[34:35], v213 offset:33792
    ds_read_b128 v[48:51], v110 offset:16384
    s_add_u32 m0, s98, 66560
    s_add_u32 s0, s26, 256
    buffer_load_dwordx4 v9, s[44:47], s26 offen lds
    s_lshl_b32 s10, 1, s3
    s_and_b32 s10, s10, 0x42
    s_cbranch_scc1 L_rare_21
L_ret_23:
    v_mfma_f32_16x16x32_bf16 v[224:227], v[200:203], v[200:203], v[224:227]
    ds_read_b64_tr_b16 v[36:37], v213 offset:36864
    ds_read_b64_tr_b16 v[38:39], v213 offset:37888
    ds_read_b128 v[52:55], v111 offset:16384
    v_mfma_f32_16x16x32_bf16 v[216:219], v[140:143], v[204:207], v[216:219]
    v_mfma_f32_16x16x32_bf16 v[224:227], v[204:207], v[204:207], v[224:227]
    s_waitcnt vmcnt(4) lgkmcnt(0)
    s_barrier
    s_cmp_eq_u32 s3, 0
    s_cbranch_scc1 L_rare_26
L_ret_28:
    v_mfma_f32_16x16x32_bf16 v[216:219], v[144:147], v[240:243], v[216:219]
    ds_read_b128 v[192:195], v16 offset:49152
    ds_read_b128 v[196:199], v17 offset:49152
    v_mfma_f32_16x16x32_bf16 v[224:227], v[240:243], v[240:243], v[224:227]
    s_add_u32 m0, s98, 98304
    s_and_b32 s27, s1, 0x1fffff
    buffer_load_dwordx4 v121, s[48:51], s27 offen lds
    v_mfma_f32_16x16x32_bf16 v[216:219], v[148:151], v[244:247], v[216:219]
    ds_read_b64_tr_b16 v[56:57], v105 offset:49152
    ds_read_b64_tr_b16 v[58:59], v105 offset:50176
    ds_read_b128 v[72:75], v112 offset:16384
    v_mfma_f32_16x16x32_bf16 v[224:227], v[244:247], v[244:247], v[224:227]
    s_add_u32 m0, s98, 99328
    s_add_u32 s1, s27, 0x20000
    buffer_load_dwordx4 v125, s[48:51], s27 offen lds
    v_mfma_f32_32x32x16_bf16 v[88:103], v[24:27], v[40:43], v[88:103]
    ds_read_b64_tr_b16 v[60:61], v105 offset:53248
    ds_read_b64_tr_b16 v[62:63], v105 offset:54272
    ds_read_b128 v[76:79], v113 offset:16384
    s_add_u32 m0, s98, 81920
    s_and_b32 s26, s0, 0x7ff
    buffer_load_dwordx4 v8, s[44:47], s26 offen lds
    v_mfma_f32_32x32x16_bf16 v[88:103], v[28:31], v[44:47], v[88:103]
    ds_read_b64_tr_b16 v[64:65], v213 offset:49152
    ds_read_b64_tr_b16 v[66:67], v213 offset:50176
    ds_read_b128 v[80:83], v114 offset:16384
    v_smfmac_f32_16x16x64_bf16 v[232:235], v[116:119], v[24:31], v120
    s_add_u32 m0, s98, 82944
    s_add_u32 s0, s26, 256
    buffer_load_dwordx4 v9, s[44:47], s26 offen lds
    v_mfma_f32_32x32x16_bf16 v[88:103], v[32:35], v[48:51], v[88:103]
    ds_read_b64_tr_b16 v[68:69], v213 offset:53248
    ds_read_b64_tr_b16 v[70:71], v213 offset:54272
    ds_read_b128 v[84:87], v115 offset:16384
    v_mfma_f32_32x32x16_bf16 v[88:103], v[36:39], v[52:55], v[88:103]
    s_waitcnt vmcnt(4) lgkmcnt(0)
    s_barrier
    v_mfma_f32_16x16x32_bf16 v[216:219], v[152:155], v[192:195], v[216:219]
    ds_read_b128 v[240:243], v18 offset:0
    ds_read_b128 v[244:247], v19 offset:0
    s_add_u32 m0, s98, 131072
    s_and_b32 s26, s0, 0x7ff
    buffer_load_dwordx4 v8, s[44:47], s26 offen lds
    v_mfma_f32_16x16x32_bf16 v[224:227], v[192:195], v[192:195], v[224:227]
    s_add_u32 m0, s98, 132096
    s_add_u32 s0, s26, 256
    buffer_load_dwordx4 v9, s[44:47], s26 offen lds
    v_mfma_f32_16x16x32_bf16 v[216:219], v[156:159], v[196:199], v[216:219]
    ds_read_b64_tr_b16 v[24:25], v104 offset:0
    ds_read_b64_tr_b16 v[26:27], v104 offset:1024
    ds_read_b128 v[40:43], v108 offset:32768
    v_mfma_f32_16x16x32_bf16 v[224:227], v[196:199], v[196:199], v[224:227]
    s_add_u32 m0, s98, 147456
    s_and_b32 s26, s0, 0x7ff
    buffer_load_dwordx4 v8, s[44:47], s26 offen lds
    v_mfma_f32_32x32x16_bf16 v[88:103], v[56:59], v[72:75], v[88:103]
    ds_read_b64_tr_b16 v[28:29], v104 offset:4096
    ds_read_b64_tr_b16 v[30:31], v104 offset:5120
    ds_read_b128 v[44:47], v109 offset:32768
    s_add_u32 m0, s98, 148480
    s_add_u32 s0, s26, 256
    buffer_load_dwordx4 v9, s[44:47], s26 offen lds
    v_mfma_f32_32x32x16_bf16 v[88:103], v[60:63], v[76:79], v[88:103]
    ds_read_b64_tr_b16 v[32:33], v212 offset:0
    ds_read_b64_tr_b16 v[34:35], v212 offset:1024
    ds_read_b128 v[48:51], v110 offset:32768
    s_add_u32 m0, s98, 114688
    s_and_b32 s27, s1, 0x1fffff
    buffer_load_dwordx4 v121, s[48:51], s27 offen lds
    v_smfmac_f32_16x16x64_bf16 v[232:235], v[116:119], v[56:63], v120
    ds_read_b64_tr_b16 v[36:37], v212 offset:4096
    ds_read_b64_tr_b16 v[38:39], v212 offset:5120
    ds_read_b128 v[52:55], v111 offset:32768
    v_mfma_f32_32x32x16_bf16 v[88:103], v[64:67], v[80:83], v[88:103]
    s_add_u32 m0, s98, 115712
    s_add_u32 s1, s27, 0x20000
    buffer_load_dwordx4 v125, s[48:51], s27 offen lds
    v_mfma_f32_32x32x16_bf16 v[88:103], v[68:71], v[84:87], v[88:103]
    s_waitcnt vmcnt(6) lgkmcnt(0)
    s_barrier
    v_mfma_f32_16x16x32_bf16 v[216:219], v[160:163], v[240:243], v[216:219]
    ds_read_b128 v[192:195], v18 offset:16384
    ds_read_b128 v[196:199], v19 offset:16384
    v_mfma_f32_16x16x32_bf16 v[224:227], v[240:243], v[240:243], v[224:227]
    s_add_u32 m0, s98, 16384
    s_and_b32 s27, s1, 0x1fffff
    buffer_load_dwordx4 v121, s[48:51], s27 offen lds
    v_mfma_f32_16x16x32_bf16 v[216:219], v[164:167], v[244:247], v[216:219]
    ds_read_b64_tr_b16 v[56:57], v105 offset:32768
    ds_read_b64_tr_b16 v[58:59], v105 offset:33792
    ds_read_b128 v[72:75], v112 offset:32768
    v_mfma_f32_16x16x32_bf16 v[224:227], v[244:247], v[244:247], v[224:227]
    s_add_u32 m0, s98, 17408
    s_add_u32 s1, s27, 0x20000
    buffer_load_dwordx4 v125, s[48:51], s27 offen lds
    v_mfma_f32_32x32x16_bf16 v[88:103], v[24:27], v[40:43], v[88:103]
    ds_read_b64_tr_b16 v[60:61], v105 offset:36864
    ds_read_b64_tr_b16 v[62:63], v105 offset:37888
    ds_read_b128 v[76:79], v113 offset:32768
    s_add_u32 m0, s98, 0
    s_and_b32 s27, s1, 0x1fffff
    buffer_load_dwordx4 v121, s[48:51], s27 offen lds
    v_mfma_f32_32x32x16_bf16 v[88:103], v[28:31], v[44:47], v[88:103]
    ds_read_b64_tr_b16 v[64:65], v213 offset:32768
    ds_read_b64_tr_b16 v[66:67], v213 offset:33792
    ds_read_b128 v[80:83], v114 offset:32768
    v_smfmac_f32_16x16x64_bf16 v[232:235], v[116:119], v[24:31], v120
    s_add_u32 m0, s98, 1024
    s_add_u32 s1, s27, 0x20000
    buffer_load_dwordx4 v125, s[48:51], s27 offen lds
    v_mfma_f32_32x32x16_bf16 v[88:103], v[32:35], v[48:51], v[88:103]
    ds_read_b64_tr_b16 v[68:69], v213 offset:36864
    ds_read_b64_tr_b16 v[70:71], v213 offset:37888
    ds_read_b128 v[84:87], v115 offset:32768
    v_mfma_f32_32x32x16_bf16 v[88:103], v[36:39], v[52:55], v[88:103]
    s_waitcnt vmcnt(4) lgkmcnt(0)
    s_barrier
    v_mfma_f32_16x16x32_bf16 v[216:219], v[168:171], v[192:195], v[216:219]
    ds_read_b128 v[240:243], v20 offset:0
    ds_read_b128 v[244:247], v21 offset:0
    v_mfma_f32_16x16x32_bf16 v[224:227], v[192:195], v[192:195], v[224:227]
    s_add_u32 m0, s98, 98304
    s_and_b32 s27, s1, 0x1fffff
    buffer_load_dwordx4 v121, s[48:51], s27 offen lds
    v_mfma_f32_16x16x32_bf16 v[216:219], v[172:175], v[196:199], v[216:219]
    ds_read_b128 v[248:251], v20 offset:16384
    ds_read_b128 v[252:255], v21 offset:16384
    v_mfma_f32_16x16x32_bf16 v[224:227], v[196:199], v[196:199], v[224:227]
    ds_read_b64_tr_b16 v[24:25], v105 offset:49152
    ds_read_b64_tr_b16 v[26:27], v105 offset:50176
    ds_read_b128 v[40:43], v108 offset:49152
    v_mfma_f32_32x32x16_bf16 v[88:103], v[56:59], v[72:75], v[88:103]
    ds_read_b64_tr_b16 v[28:29], v105 offset:53248
    ds_read_b64_tr_b16 v[30:31], v105 offset:54272
    ds_read_b128 v[44:47], v109 offset:49152
    v_mfma_f32_32x32x16_bf16 v[88:103], v[60:63], v[76:79], v[88:103]
    s_add_u32 m0, s98, 99328
    s_add_u32 s1, s27, 0x20000
    buffer_load_dwordx4 v125, s[48:51], s27 offen lds
    ds_read_b64_tr_b16 v[32:33], v213 offset:49152
    ds_read_b64_tr_b16 v[34:35], v213 offset:50176
    ds_read_b128 v[48:51], v110 offset:49152
    s_waitcnt lgkmcnt(9)
    v_mfma_f32_16x16x32_bf16 v[216:219], v[176:179], v[240:243], v[216:219]
    v_mfma_f32_16x16x32_bf16 v[224:227], v[240:243], v[240:243], v[224:227]
    v_mfma_f32_16x16x32_bf16 v[216:219], v[180:183], v[244:247], v[216:219]
    v_mfma_f32_16x16x32_bf16 v[224:227], v[244:247], v[244:247], v[224:227]
    v_mfma_f32_16x16x32_bf16 v[216:219], v[184:187], v[248:251], v[216:219]
    v_mfma_f32_16x16x32_bf16 v[224:227], v[248:251], v[248:251], v[224:227]
    v_mfma_f32_16x16x32_bf16 v[216:219], v[188:191], v[252:255], v[216:219]
    v_mfma_f32_16x16x32_bf16 v[224:227], v[252:255], v[252:255], v[224:227]
    s_lshl_b32 s11, s91, 12
    s_add_u32 s11, s11, 32768
    v_lshl_add_u32 v14, v7, 8, s11
    v_lshl_add_u32 v14, v7, 4, v14
    s_lshl_b32 s10, s90, 6
    v_xor_b32 v14, s10, v14
    v_lshlrev_b32 v15, 4, v6
    v_xor_b32 v15, v15, v14
    v_xor_b32 v14, 48, v14
    s_cmp_eq_u32 s3, 0
    s_cbranch_scc1 L_rare_33
L_ret_35:
    v_smfmac_f32_16x16x64_bf16 v[232:235], v[116:119], v[56:63], v120
    v_mfma_f32_32x32x16_bf16 v[88:103], v[64:67], v[80:83], v[88:103]
    ds_read_b64_tr_b16 v[36:37], v213 offset:53248
    ds_read_b64_tr_b16 v[38:39], v213 offset:54272
    ds_read_b128 v[52:55], v111 offset:49152
    v_mfma_f32_32x32x16_bf16 v[88:103], v[68:71], v[84:87], v[88:103]
    ds_write_b128 v15, v[216:219]
    s_mov_b32 exec_lo, 0x00f0000f
    s_mov_b32 exec_hi, 0xf0000f00
    ds_write_b128 v14, v[224:227]
    s_mov_b64 exec, -1
    s_cmp_eq_u32 s3, 0
    s_cbranch_scc1 L_rare_37
L_ret_39:
    s_cmp_eq_u32 s3, 0
    s_cbranch_scc1 L_wd_41
    s_waitcnt vmcnt(2) lgkmcnt(0)
L_we_40:
    s_barrier
    v_lshlrev_b32 v14, 8, v1
    v_lshl_add_u32 v14, v7, 4, v14
    v_and_b32 v15, 3, v1
    v_lshl_add_u32 v15, v15, 2, v14
    s_cmp_eq_u32 s3, 0
    s_cbranch_scc1 L_rare_43
L_ret_45:
    v_xor_b32 v195, 32, v14
    ds_read_b64 v[144:145], v195 offset:32768
    v_xor_b32 v196, 96, v14
    ds_read_b64 v[146:147], v196 offset:32768
    v_xor_b32 v197, 48, v15
    ds_read_b32 v148, v197 offset:32768
    v_xor_b32 v198, 112, v15
    ds_read_b32 v149, v198 offset:32768
    v_mfma_f32_32x32x16_bf16 v[88:103], v[24:27], v[40:43], v[88:103]
    ds_read_b64_tr_b16 v[56:57], v104 offset:16384
    ds_read_b64_tr_b16 v[58:59], v104 offset:17408
    ds_read_b128 v[72:75], v112 offset:49152
    s_add_u32 m0, s98, 114688
    s_and_b32 s27, s1, 0x1fffff
    buffer_load_dwordx4 v121, s[48:51], s27 offen lds
    v_mfma_f32_32x32x16_bf16 v[88:103], v[28:31], v[44:47], v[88:103]
    ds_read_b64_tr_b16 v[60:61], v104 offset:20480
    ds_read_b64_tr_b16 v[62:63], v104 offset:21504
    ds_read_b128 v[76:79], v113 offset:49152
    ds_read_b64_tr_b16 v[64:65], v212 offset:16384
    ds_read_b64_tr_b16 v[66:67], v212 offset:17408
    ds_read_b128 v[80:83], v114 offset:49152
    s_waitcnt lgkmcnt(9)
    v_add_f32 v15, v145, v147
    v_add_f32 v16, v148, v149
    v_mul_f32 v15, 0x3a800000, v15
    v_mul_f32 v16, 0x3a800000, v16
    v_fma_f32 v16, -v15, v15, v16
    v_max_f32 v16, 0, v16
    v_cvt_pk_bf16_f32 v16, v16, v16
    v_and_b32 v16, 0xffff0000, v16
    v_add_f32 v16, 0x3727c5ac, v16
    v_cvt_pk_bf16_f32 v16, v16, v16
    v_and_b32 v16, 0xffff0000, v16
    v_sqrt_f32 v16, v16
    v_cvt_pk_bf16_f32 v17, v15, v15
    v_and_b32 v17, 0xffff0000, v17
    v_cvt_pk_bf16_f32 v16, v16, v16
    v_and_b32 v16, 0xffff0000, v16
    v_rcp_f32 v18, v16
    s_cmp_eq_u32 s3, 0
    s_cbranch_scc1 L_rare_48
L_ret_50:
    s_setprio 0
    v_mov_b32 v20, v17
    v_mov_b32 v21, v18
    s_nop 0
    v_permlane32_swap_b32 v17, v20
    v_permlane32_swap_b32 v18, v21
    s_cmp_eq_u32 s90, 0
    s_cselect_b64 vcc, -1, 0
    v_cndmask_b32 v3, v20, v17, vcc
    v_cndmask_b32 v4, v21, v18, vcc
    v_smfmac_f32_16x16x64_bf16 v[232:235], v[116:119], v[24:31], v120
    s_add_u32 m0, s98, 115712
    s_add_u32 s1, s27, 0x20000
    buffer_load_dwordx4 v125, s[48:51], s27 offen lds
    v_mfma_f32_32x32x16_bf16 v[88:103], v[32:35], v[48:51], v[88:103]
    ds_read_b64_tr_b16 v[68:69], v212 offset:20480
    ds_read_b64_tr_b16 v[70:71], v212 offset:21504
    ds_read_b128 v[84:87], v115 offset:49152
    v_mfma_f32_32x32x16_bf16 v[88:103], v[36:39], v[52:55], v[88:103]
    s_waitcnt lgkmcnt(0)
    v_mfma_f32_32x32x16_bf16 v[88:103], v[56:59], v[72:75], v[88:103]
    v_add_u32 v108, 65536, v108
    v_add_u32 v109, 65536, v109
    v_add_u32 v110, 65536, v110
    v_add_u32 v111, 65536, v111
    v_add_u32 v112, 65536, v112
    v_add_u32 v113, 65536, v113
    v_add_u32 v114, 65536, v114
    v_add_u32 v115, 65536, v115
    ds_read_b64_tr_b16 v[24:25], v104 offset:0
    ds_read_b64_tr_b16 v[26:27], v104 offset:1024
    ds_read_b128 v[40:43], v108 offset:0
    ds_read_b64_tr_b16 v[28:29], v104 offset:4096
    ds_read_b64_tr_b16 v[30:31], v104 offset:5120
    ds_read_b128 v[44:47], v109 offset:0
    v_mfma_f32_32x32x16_bf16 v[88:103], v[60:63], v[76:79], v[88:103]
    ds_read_b64_tr_b16 v[32:33], v212 offset:0
    ds_read_b64_tr_b16 v[34:35], v212 offset:1024
    ds_read_b128 v[48:51], v110 offset:0
    v_smfmac_f32_16x16x64_bf16 v[232:235], v[116:119], v[56:63], v120
    v_mfma_f32_32x32x16_bf16 v[88:103], v[64:67], v[80:83], v[88:103]
    ds_read_b64_tr_b16 v[36:37], v212 offset:4096
    ds_read_b64_tr_b16 v[38:39], v212 offset:5120
    ds_read_b128 v[52:55], v111 offset:0
    v_mfma_f32_32x32x16_bf16 v[88:103], v[68:71], v[84:87], v[88:103]
    s_cmp_eq_u32 s3, 0
    s_cbranch_scc1 L_wd_52
    s_waitcnt vmcnt(2) lgkmcnt(0)
L_we_51:
    s_barrier
    v_mfma_f32_32x32x16_bf16 v[88:103], v[24:27], v[40:43], v[88:103]
    ds_read_b64_tr_b16 v[56:57], v105 offset:32768
    ds_read_b64_tr_b16 v[58:59], v105 offset:33792
    ds_read_b128 v[72:75], v112 offset:0
    s_add_u32 m0, s98, 32768
    s_and_b32 s27, s1, 0x1fffff
    buffer_load_dwordx4 v121, s[48:51], s27 offen lds
    ds_read_b64_tr_b16 v[60:61], v105 offset:36864
    ds_read_b64_tr_b16 v[62:63], v105 offset:37888
    ds_read_b128 v[76:79], v113 offset:0
    v_mfma_f32_32x32x16_bf16 v[88:103], v[28:31], v[44:47], v[88:103]
    s_add_u32 m0, s98, 33792
    s_add_u32 s1, s27, 0x20000
    buffer_load_dwordx4 v125, s[48:51], s27 offen lds
    ds_read_b64_tr_b16 v[64:65], v213 offset:32768
    ds_read_b64_tr_b16 v[66:67], v213 offset:33792
    ds_read_b128 v[80:83], v114 offset:0
    v_smfmac_f32_16x16x64_bf16 v[232:235], v[116:119], v[24:31], v120
    s_add_u32 m0, s98, 49152
    s_and_b32 s27, s1, 0x1fffff
    buffer_load_dwordx4 v121, s[48:51], s27 offen lds
    v_mfma_f32_32x32x16_bf16 v[88:103], v[32:35], v[48:51], v[88:103]
    ds_read_b64_tr_b16 v[68:69], v213 offset:36864
    ds_read_b64_tr_b16 v[70:71], v213 offset:37888
    ds_read_b128 v[84:87], v115 offset:0
    s_add_u32 m0, s98, 50176
    s_add_u32 s1, s27, 0x20000
    buffer_load_dwordx4 v125, s[48:51], s27 offen lds
    v_mfma_f32_32x32x16_bf16 v[88:103], v[36:39], v[52:55], v[88:103]
    s_cmp_eq_u32 s3, 0
    s_cbranch_scc1 L_rare_54
L_ret_56:
    s_cmp_eq_u32 s3, 0
    s_cbranch_scc1 L_wd_58
    s_waitcnt vmcnt(4) lgkmcnt(0)
L_we_57:
    s_barrier
    v_mfma_f32_32x32x16_bf16 v[88:103], v[56:59], v[72:75], v[88:103]
    ds_read_b64_tr_b16 v[24:25], v105 offset:49152
    ds_read_b64_tr_b16 v[26:27], v105 offset:50176
    ds_read_b128 v[40:43], v108 offset:16384
    s_add_u32 m0, s98, 98304
    s_and_b32 s27, s1, 0x1fffff
    buffer_load_dwordx4 v121, s[48:51], s27 offen lds
    ds_read_b64_tr_b16 v[28:29], v105 offset:53248
    ds_read_b64_tr_b16 v[30:31], v105 offset:54272
    ds_read_b128 v[44:47], v109 offset:16384
    v_mfma_f32_32x32x16_bf16 v[88:103], v[60:63], v[76:79], v[88:103]
    s_add_u32 m0, s98, 99328
    s_add_u32 s1, s27, 0x20000
    buffer_load_dwordx4 v125, s[48:51], s27 offen lds
    ds_read_b64_tr_b16 v[32:33], v213 offset:49152
    ds_read_b64_tr_b16 v[34:35], v213 offset:50176
    ds_read_b128 v[48:51], v110 offset:16384
    v_smfmac_f32_16x16x64_bf16 v[232:235], v[116:119], v[56:63], v120
    s_add_u32 m0, s98, 65536
    s_and_b32 s27, s1, 0x1fffff
    buffer_load_dwordx4 v121, s[48:51], s27 offen lds
    v_mfma_f32_32x32x16_bf16 v[88:103], v[64:67], v[80:83], v[88:103]
    ds_read_b64_tr_b16 v[36:37], v213 offset:53248
    ds_read_b64_tr_b16 v[38:39], v213 offset:54272
    ds_read_b128 v[52:55], v111 offset:16384
    s_add_u32 m0, s98, 66560
    s_add_u32 s1, s27, 0x20000
    buffer_load_dwordx4 v125, s[48:51], s27 offen lds
    v_mfma_f32_32x32x16_bf16 v[88:103], v[68:71], v[84:87], v[88:103]
    s_cmp_lt_u32 s9, 28
    s_cselect_b32 s60, s3, 99
    v_bfe_u32 v123, v1, 2, 2
    v_lshl_add_u32 v123, v6, 3, v123
    v_and_b32 v124, 3, v1
    v_lshlrev_b32 v124, 3, v124
    v_lshl_add_u32 v123, v123, 7, v124
    v_bfe_u32 v124, v1, 3, 2
    v_lshl_add_u32 v123, v124, 5, v123
    s_lshl_b32 s10, s3, 12
    s_add_u32 s10, s10, 65536
    v_add_u32 v176, s10, v123
    v_bfe_u32 v123, v1, 2, 2
    v_lshlrev_b32 v123, 6, v123
    v_lshrrev_b32 v124, 5, v1
    v_lshl_add_u32 v123, v124, 9, v123
    v_bfe_u32 v124, v1, 4, 1
    v_lshl_add_u32 v123, v124, 5, v123
    v_and_b32 v124, 3, v1
    v_lshl_add_u32 v123, v124, 3, v123
    s_add_u32 s10, s98, 131072
    v_add_u32 v177, s10, v123
    s_cmp_eq_u32 s3, 0
    s_cbranch_scc1 L_wd_60
    s_waitcnt vmcnt(6) lgkmcnt(0)
L_we_59:
    s_barrier
    v_mfma_f32_32x32x16_bf16 v[88:103], v[24:27], v[40:43], v[88:103]
    ds_read_b64_tr_b16 v[56:57], v104 offset:32768
    ds_read_b64_tr_b16 v[58:59], v104 offset:33792
    ds_read_b128 v[72:75], v112 offset:16384
    s_add_u32 m0, s98, 114688
    s_and_b32 s27, s1, 0x1fffff
    buffer_load_dwordx4 v121, s[48:51], s27 offen lds
    v_mfma_f32_32x32x16_bf16 v[88:103], v[28:31], v[44:47], v[88:103]
    ds_read_b64_tr_b16 v[60:61], v104 offset:36864
    ds_read_b64_tr_b16 v[62:63], v104 offset:37888
    ds_read_b128 v[76:79], v113 offset:16384
    ds_read_b64_tr_b16 v[64:65], v212 offset:32768
    ds_read_b64_tr_b16 v[66:67], v212 offset:33792
    ds_read_b128 v[80:83], v114 offset:16384
    v_smfmac_f32_16x16x64_bf16 v[232:235], v[116:119], v[24:31], v120
    s_add_u32 m0, s98, 115712
    s_add_u32 s1, s27, 0x20000
    buffer_load_dwordx4 v125, s[48:51], s27 offen lds
    v_mfma_f32_32x32x16_bf16 v[88:103], v[32:35], v[48:51], v[88:103]
    ds_read_b64_tr_b16 v[68:69], v212 offset:36864
    ds_read_b64_tr_b16 v[70:71], v212 offset:37888
    ds_read_b128 v[84:87], v115 offset:16384
    v_mfma_f32_32x32x16_bf16 v[88:103], v[36:39], v[52:55], v[88:103]
    v_lshrrev_b32 v123, 2, v1
    v_xor_b32 v123, v123, v6
    v_and_b32 v123, 1, v123
    v_cmp_eq_u32 vcc, 0, v123
    v_lshrrev_b32 v124, 5, v1
    s_lshl_b32 s10, s3, 7
    s_add_u32 s10, s10, 155648
    v_lshl_add_u32 v124, v124, 4, s10
    v_mov_b32 v123, 150272
    v_cndmask_b32 v178, v123, v124, vcc
    v_lshl_add_u32 v183, v1, 1, s10
    s_min_u32 s10, s3, 6
    s_mul_i32 s11, s7, 7
    s_add_u32 s10, s10, s11
    s_lshl_b32 s24, s10, 12
    s_add_u32 s24, s24, 278528
    s_lshl_b32 s10, s6, 9
    s_lshl_b32 s11, s3, 6
    s_add_u32 s10, s10, s11
    s_add_u32 s10, s10, 147456
    v_lshl_add_u32 v179, v6, 4, s10
    s_lshl_b32 s10, s3, 2
    s_add_u32 s10, s10, 151552
    v_lshl_add_u32 v180, v7, 5, s10
    v_lshlrev_b32 v181, 2, v0
    s_cmp_eq_u32 s3, 0
    s_cbranch_scc1 L_wd_62
    s_waitcnt vmcnt(6) lgkmcnt(0)
L_we_61:
    s_barrier
    v_mfma_f32_32x32x16_bf16 v[88:103], v[56:59], v[72:75], v[88:103]
    v_add_u32 v108, 65536, v108
    v_add_u32 v109, 65536, v109
    v_add_u32 v110, 65536, v110
    v_add_u32 v111, 65536, v111
    v_add_u32 v112, 65536, v112
    v_add_u32 v113, 65536, v113
    v_add_u32 v114, 65536, v114
    v_add_u32 v115, 65536, v115
    ds_read_b64_tr_b16 v[24:25], v104 offset:49152
    ds_read_b64_tr_b16 v[26:27], v104 offset:50176
    ds_read_b128 v[40:43], v108 offset:0
    ds_read_b64_tr_b16 v[28:29], v104 offset:53248
    ds_read_b64_tr_b16 v[30:31], v104 offset:54272
    ds_read_b128 v[44:47], v109 offset:0
    v_mfma_f32_32x32x16_bf16 v[88:103], v[60:63], v[76:79], v[88:103]
    ds_read_b64_tr_b16 v[32:33], v212 offset:49152
    ds_read_b64_tr_b16 v[34:35], v212 offset:50176
    ds_read_b128 v[48:51], v110 offset:0
    v_smfmac_f32_16x16x64_bf16 v[232:235], v[116:119], v[56:63], v120
    v_mfma_f32_32x32x16_bf16 v[88:103], v[64:67], v[80:83], v[88:103]
    ds_read_b64_tr_b16 v[36:37], v212 offset:53248
    ds_read_b64_tr_b16 v[38:39], v212 offset:54272
    ds_read_b128 v[52:55], v111 offset:0
    v_mfma_f32_32x32x16_bf16 v[88:103], v[68:71], v[84:87], v[88:103]
    v_and_b32 v123, 31, v1
    v_lshrrev_b32 v124, 5, v1
    v_lshlrev_b32 v124, 4, v124
    v_lshl_add_u32 v182, v123, 11, v124
    s_lshl_b32 s52, s5, 8
    s_lshl_b32 s53, s90, 16
    s_add_u32 s53, s53, s95
    s_add_u32 s53, s53, s52
    s_lshl_b32 s10, s91, 6
    s_add_u32 s53, s53, s10
    s_waitcnt vmcnt(4) lgkmcnt(0)
    s_barrier
    s_cmp_eq_u32 s3, 0
    s_cbranch_scc1 L_rare_65
L_ret_67:
    v_mfma_f32_32x32x16_bf16 v[88:103], v[24:27], v[40:43], v[88:103]
    ds_read_b64_tr_b16 v[56:57], v105 offset:32768
    ds_read_b64_tr_b16 v[58:59], v105 offset:33792
    ds_read_b128 v[72:75], v112 offset:0
    ds_read_b64_tr_b16 v[60:61], v105 offset:36864
    ds_read_b64_tr_b16 v[62:63], v105 offset:37888
    ds_read_b128 v[76:79], v113 offset:0
    v_mfma_f32_32x32x16_bf16 v[88:103], v[28:31], v[44:47], v[88:103]
    ds_read_b64_tr_b16 v[64:65], v213 offset:32768
    ds_read_b64_tr_b16 v[66:67], v213 offset:33792
    ds_read_b128 v[80:83], v114 offset:0
    v_smfmac_f32_16x16x64_bf16 v[232:235], v[116:119], v[24:31], v120
    v_mfma_f32_32x32x16_bf16 v[88:103], v[32:35], v[48:51], v[88:103]
    ds_read_b64_tr_b16 v[68:69], v213 offset:36864
    ds_read_b64_tr_b16 v[70:71], v213 offset:37888
    ds_read_b128 v[84:87], v115 offset:0
    v_mfma_f32_32x32x16_bf16 v[88:103], v[36:39], v[52:55], v[88:103]
    s_lshl_b32 s10, s3, 8
    s_add_u32 s10, s10, 81920
    v_lshl_add_u32 v14, v1, 2, s10
    v_add_f32 v15, v232, v233
    ds_write_b32 v14, v15
    v_xor_b32 v229, 0x400, v14
    s_cmp_eq_u32 s3, 0
    s_cbranch_scc1 L_wd_71
    s_waitcnt vmcnt(2) lgkmcnt(0)
L_we_70:
    s_barrier
    ds_read_b32 v228, v229
    v_mfma_f32_32x32x16_bf16 v[88:103], v[56:59], v[72:75], v[88:103]
    ds_read_b64_tr_b16 v[24:25], v105 offset:0
    ds_read_b64_tr_b16 v[26:27], v105 offset:1024
    ds_read_b128 v[40:43], v108 offset:16384
    v_mfma_f32_32x32x16_bf16 v[88:103], v[60:63], v[76:79], v[88:103]
    ds_read_b64_tr_b16 v[28:29], v105 offset:4096
    ds_read_b64_tr_b16 v[30:31], v105 offset:5120
    ds_read_b128 v[44:47], v109 offset:16384
    v_smfmac_f32_16x16x64_bf16 v[232:235], v[116:119], v[56:63], v120
    ds_read_b64_tr_b16 v[32:33], v213 offset:0
    ds_read_b64_tr_b16 v[34:35], v213 offset:1024
    ds_read_b128 v[48:51], v110 offset:16384
    v_mfma_f32_32x32x16_bf16 v[88:103], v[64:67], v[80:83], v[88:103]
    ds_read_b64_tr_b16 v[36:37], v213 offset:4096
    ds_read_b64_tr_b16 v[38:39], v213 offset:5120
    ds_read_b128 v[52:55], v111 offset:16384
    v_mfma_f32_32x32x16_bf16 v[88:103], v[68:71], v[84:87], v[88:103]
    v_smfmac_f32_16x16x64_bf16 v[232:235], v[116:119], v[64:71], v120
    s_cmp_eq_u32 s3, 0
    s_cbranch_scc1 L_rare_73
L_ret_75:
    s_cmp_eq_u32 s3, 0
    s_cbranch_scc1 L_wd_78
    s_waitcnt vmcnt(0) lgkmcnt(0)
L_we_77:
    s_barrier
    v_mfma_f32_32x32x16_bf16 v[88:103], v[24:27], v[40:43], v[88:103]
    ds_read_b64_tr_b16 v[56:57], v105 offset:49152
    ds_read_b64_tr_b16 v[58:59], v105 offset:50176
    ds_read_b128 v[72:75], v112 offset:16384
    s_add_u32 m0, s98, 0
    s_nop 0
    buffer_load_dwordx4 v2, s[84:87], s55 offen offset:0 sc1 lds
    v_mfma_f32_32x32x16_bf16 v[88:103], v[28:31], v[44:47], v[88:103]
    ds_read_b64_tr_b16 v[60:61], v105 offset:53248
    ds_read_b64_tr_b16 v[62:63], v105 offset:54272
    ds_read_b128 v[76:79], v113 offset:16384
    s_add_u32 m0, s98, 0
    s_add_u32 s0, s55, 16384
    buffer_load_dwordx4 v2, s[84:87], s55 offen offset:1024 sc1 lds
    v_smfmac_f32_16x16x64_bf16 v[232:235], v[116:119], v[24:31], v120
    ds_read_b64_tr_b16 v[64:65], v213 offset:49152
    ds_read_b64_tr_b16 v[66:67], v213 offset:50176
    ds_read_b128 v[80:83], v114 offset:16384
    v_mfma_f32_32x32x16_bf16 v[88:103], v[32:35], v[48:51], v[88:103]
    s_add_u32 m0, s98, 16384
    s_and_b32 s55, s0, 0x3ffff
    buffer_load_dwordx4 v2, s[84:87], s55 offen offset:0 sc1 lds
    ds_read_b64_tr_b16 v[68:69], v213 offset:53248
    ds_read_b64_tr_b16 v[70:71], v213 offset:54272
    ds_read_b128 v[84:87], v115 offset:16384
    v_mfma_f32_32x32x16_bf16 v[88:103], v[36:39], v[52:55], v[88:103]
    s_add_u32 m0, s98, 16384
    s_add_u32 s0, s55, 16384
    buffer_load_dwordx4 v2, s[84:87], s55 offen offset:1024 sc1 lds
    v_smfmac_f32_16x16x64_bf16 v[232:235], v[116:119], v[32:39], v120
    s_waitcnt lgkmcnt(0)
    v_mfma_f32_32x32x16_bf16 v[88:103], v[56:59], v[72:75], v[88:103]
    v_mfma_f32_32x32x16_bf16 v[88:103], v[60:63], v[76:79], v[88:103]
    v_smfmac_f32_16x16x64_bf16 v[232:235], v[116:119], v[56:63], v120
    v_mfma_f32_32x32x16_bf16 v[88:103], v[64:67], v[80:83], v[88:103]
    v_mfma_f32_32x32x16_bf16 v[88:103], v[68:71], v[84:87], v[88:103]
    v_smfmac_f32_16x16x64_bf16 v[232:235], v[116:119], v[64:71], v120
    v_xor_b32 v28, 0x80000000, v3
    v_lshrrev_b32 v29, 16, v28
    v_or_b32 v28, v28, v29
    v_mov_b32 v30, 0
    v_mov_b32 v31, 0
    v_mov_b32 v27, 0
    s_nop 1
    v_add_f32 v232, v232, v233
    s_mov_b32 exec_lo, 0
    v_mov_b32 v232, v228
    s_mov_b32 exec_lo, -1
    v_and_b32 v24, 0xffff0000, v232
    v_sub_f32 v232, v232, v24
    v_and_b32 v26, 0xffff0000, v232
    v_sub_f32 v232, v232, v26
    v_lshrrev_b32 v25, 16, v232
    v_lshrrev_b32 v24, 16, v24
    v_or_b32 v24, v24, v26
    v_mov_b32 v26, 0
    s_nop 1
    v_mfma_f32_32x32x16_bf16 v[88:103], v[24:27], v[28:31], v[88:103]
    v_mul_f32 v32, 0x3e8293ee, v4
    s_nop 10
    v_mul_f32 v88, v88, v32
    v_mul_f32 v89, v89, v32
    v_mul_f32 v90, v90, v32
    v_mul_f32 v91, v91, v32
    v_mul_f32 v92, v92, v32
    v_mul_f32 v93, v93, v32
    v_mul_f32 v94, v94, v32
    v_mul_f32 v95, v95, v32
    v_mul_f32 v96, v96, v32
    v_mul_f32 v97, v97, v32
    v_mul_f32 v98, v98, v32
    v_mul_f32 v99, v99, v32
    v_mul_f32 v100, v100, v32
    v_mul_f32 v101, v101, v32
    v_mul_f32 v102, v102, v32
    v_mul_f32 v103, v103, v32
    v_cvt_pk_bf16_f32 v8, v88, v89
    v_cvt_pk_bf16_f32 v9, v90, v91
    v_cvt_pk_bf16_f32 v10, v92, v93
    v_cvt_pk_bf16_f32 v11, v94, v95
    v_cvt_pk_bf16_f32 v12, v96, v97
    v_cvt_pk_bf16_f32 v13, v98, v99
    v_cvt_pk_bf16_f32 v14, v100, v101
    v_cvt_pk_bf16_f32 v15, v102, v103
    s_lshl_b32 s27, s5, 18
    s_add_u32 s27, s27, s52
    s_waitcnt lgkmcnt(0)
    s_waitcnt vmcnt(2)
    s_barrier
    ds_read_b128 v[100:103], v2 offset:0
    ds_read_b128 v[104:107], v2 offset:1024
    ds_read_b128 v[108:111], v2 offset:2048
    v_mov_b32 v96, 0
    v_mov_b32 v97, 0
    v_mov_b32 v98, 0
    v_mov_b32 v99, 0
    s_waitcnt lgkmcnt(1)
    v_mfma_f32_32x32x16_bf16 v[32:47], v[100:103], v[8:11], 0
    v_mfma_f32_32x32x16_bf16 v[32:47], v[104:107], v[12:15], v[32:47]
    ds_read_b128 v[100:103], v2 offset:4096
    ds_read_b128 v[104:107], v2 offset:5120
    s_cmp_eq_u32 s3, 0
    s_cbranch_scc0 L_rx_82
    s_mov_b32 s10, 270336
    buffer_load_dwordx4 v[200:203], v2, s[84:87], s10 offen sc1
L_rx_82:
    s_nop 7
    v_max3_f32 v123, v32, v33, v34
    v_max3_f32 v123, v123, v35, v36
    v_max3_f32 v123, v123, v37, v38
    v_max3_f32 v123, v123, v39, v40
    v_max3_f32 v123, v123, v41, v42
    v_max3_f32 v123, v123, v43, v44
    v_max3_f32 v123, v123, v45, v46
    v_max_f32 v123, v123, v47
    v_mov_b32 v124, v123
    s_nop 1
    v_permlane32_swap_b32 v123, v124
    v_max_f32 v123, v123, v124
    v_sub_f32 v16, 0, v123
    v_sub_f32 v32, v32, v123
    v_sub_f32 v17, 0, v123
    v_sub_f32 v33, v33, v123
    v_sub_f32 v18, 0, v123
    v_sub_f32 v34, v34, v123
    v_sub_f32 v19, 0, v123
    v_sub_f32 v35, v35, v123
    v_sub_f32 v20, 0, v123
    v_sub_f32 v36, v36, v123
    v_sub_f32 v21, 0, v123
    v_sub_f32 v37, v37, v123
    v_sub_f32 v22, 0, v123
    v_sub_f32 v38, v38, v123
    v_sub_f32 v23, 0, v123
    v_sub_f32 v39, v39, v123
    v_sub_f32 v24, 0, v123
    v_sub_f32 v40, v40, v123
    v_sub_f32 v25, 0, v123
    v_sub_f32 v41, v41, v123
    v_sub_f32 v26, 0, v123
    v_sub_f32 v42, v42, v123
    v_sub_f32 v27, 0, v123
    v_sub_f32 v43, v43, v123
    v_sub_f32 v28, 0, v123
    v_sub_f32 v44, v44, v123
    v_sub_f32 v29, 0, v123
    v_sub_f32 v45, v45, v123
    v_sub_f32 v30, 0, v123
    v_sub_f32 v46, v46, v123
    v_sub_f32 v31, 0, v123
    v_sub_f32 v47, v47, v123
    s_waitcnt lgkmcnt(0)
    v_mfma_f32_32x32x16_bf16 v[48:63], v[100:103], v[8:11], v[16:31]
    ds_read_b128 v[100:103], v2 offset:8192
    v_exp_f32 v32, v32
    v_exp_f32 v33, v33
    v_exp_f32 v34, v34
    v_exp_f32 v35, v35
    v_mfma_f32_32x32x16_bf16 v[48:63], v[104:107], v[12:15], v[48:63]
    ds_read_b128 v[104:107], v2 offset:9216
    v_mov_b32 v123, 0
    v_lshrrev_b32 v124, 2, v2
    v_add_u32 v124, 150272, v124
    ds_write_b32 v124, v123
    v_exp_f32 v36, v36
    v_exp_f32 v37, v37
    v_exp_f32 v38, v38
    v_exp_f32 v39, v39
    ds_read_b128 v[112:115], v2 offset:3072
    v_cvt_pk_bf16_f32 v64, v32, v33
    v_cvt_pk_bf16_f32 v65, v34, v35
    v_cvt_pk_bf16_f32 v66, v36, v37
    v_cvt_pk_bf16_f32 v67, v38, v39
    v_exp_f32 v40, v40
    v_exp_f32 v41, v41
    s_waitcnt lgkmcnt(2)
    v_exp_f32 v42, v42
    v_exp_f32 v43, v43
    v_exp_f32 v44, v44
    v_exp_f32 v45, v45
    v_mfma_f32_32x32x16_bf16 v[80:95], v[108:111], v[64:67], 0
    ds_read_b128 v[108:111], v2 offset:6144
    s_lshl_b32 s10, s2, 13
    s_lshl_b32 s11, s3, 10
    s_add_u32 s10, s10, s11
    buffer_load_dwordx4 v[224:227], v2, s[56:59], s10 offen
    v_exp_f32 v46, v46
    v_exp_f32 v47, v47
    s_setprio 0
    v_cvt_pk_bf16_f32 v68, v40, v41
    v_cvt_pk_bf16_f32 v69, v42, v43
    v_cvt_pk_bf16_f32 v70, v44, v45
    v_cvt_pk_bf16_f32 v71, v46, v47
    v_mfma_f32_32x32x16_bf16 v[32:47], v[100:103], v[8:11], v[16:31]
    ds_read_b128 v[100:103], v2 offset:12288
    v_exp_f32 v48, v48
    v_exp_f32 v49, v49
    v_exp_f32 v50, v50
    v_exp_f32 v51, v51
    v_mfma_f32_32x32x16_bf16 v[32:47], v[104:107], v[12:15], v[32:47]
    ds_read_b128 v[104:107], v2 offset:13312
    v_exp_f32 v52, v52
    v_exp_f32 v53, v53
    v_exp_f32 v54, v54
    v_exp_f32 v55, v55
    s_waitcnt lgkmcnt(3)
    v_mfma_f32_32x32x16_bf16 v[80:95], v[112:115], v[68:71], v[80:95]
    ds_read_b128 v[112:115], v2 offset:7168
    v_cvt_pk_bf16_f32 v72, v48, v49
    v_cvt_pk_bf16_f32 v73, v50, v51
    v_cvt_pk_bf16_f32 v74, v52, v53
    v_cvt_pk_bf16_f32 v75, v54, v55
    v_exp_f32 v56, v56
    v_exp_f32 v57, v57
    v_smfmac_f32_16x16x64_bf16 v[96:99], v[116:119], v[64:71], v120
    s_waitcnt lgkmcnt(1)
    v_exp_f32 v58, v58
    v_exp_f32 v59, v59
    v_exp_f32 v60, v60
    v_exp_f32 v61, v61
    v_mfma_f32_32x32x16_bf16 v[80:95], v[108:111], v[72:75], v[80:95]
    ds_read_b128 v[108:111], v2 offset:10240
    v_exp_f32 v62, v62
    v_exp_f32 v63, v63
    s_setprio 3
    v_cvt_pk_bf16_f32 v76, v56, v57
    v_cvt_pk_bf16_f32 v77, v58, v59
    v_cvt_pk_bf16_f32 v78, v60, v61
    v_cvt_pk_bf16_f32 v79, v62, v63
    v_mfma_f32_32x32x16_bf16 v[48:63], v[100:103], v[8:11], v[16:31]
    s_cmp_eq_u32 s3, 0
    s_cbranch_scc0 L_rx_86
    s_waitcnt vmcnt(1)
    v_and_b32 v200, v200, v201
    v_and_b32 v202, v202, v203
    v_and_b32 v200, v200, v202
    v_cmp_ne_u32 vcc, 1, v200
    s_nop 0
    s_cbranch_vccz L_rx_86
    s_mov_b32 s99, 200000
    s_mov_b32 s10, 270336
L_poll_88:
    buffer_load_dwordx4 v[200:203], v2, s[84:87], s10 offen sc1
    s_waitcnt vmcnt(0)
    v_and_b32 v200, v200, v201
    v_and_b32 v202, v202, v203
    v_and_b32 v200, v200, v202
    v_cmp_ne_u32 vcc, 1, v200
    s_sub_u32 s99, s99, 1
    s_cbranch_scc1 L_rx_86
    s_cbranch_vccnz L_poll_88
L_rx_86:
    s_waitcnt vmcnt(2)
    s_cmp_eq_u32 s3, 0
    s_cbranch_scc1 L_we_89
    s_waitcnt vmcnt(1)
L_we_89:
    s_barrier
    ds_read_b128 v[100:103], v2 offset:16384
    v_exp_f32 v32, v32
    v_exp_f32 v33, v33
    v_exp_f32 v34, v34
    v_exp_f32 v35, v35
    v_mfma_f32_32x32x16_bf16 v[48:63], v[104:107], v[12:15], v[48:63]
    ds_read_b128 v[104:107], v2 offset:17408
    s_cmp_eq_u32 s3, 1
    s_cbranch_scc0 L_rx_92
    v_and_b32 v123, 0x1f0, v2
    s_mov_b32 s10, 262144
    buffer_load_dwordx4 v[192:195], v123, s[84:87], s10 offen sc1
L_rx_92:
    v_exp_f32 v36, v36
    v_exp_f32 v37, v37
    v_exp_f32 v38, v38
    v_exp_f32 v39, v39
    s_waitcnt lgkmcnt(3)
    v_mfma_f32_32x32x16_bf16 v[80:95], v[112:115], v[76:79], v[80:95]
    ds_read_b128 v[112:115], v2 offset:11264
    s_add_u32 m0, s98, 32768
    s_and_b32 s55, s0, 0x3ffff
    buffer_load_dwordx4 v2, s[84:87], s55 offen offset:0 sc1 lds
    v_cvt_pk_bf16_f32 v64, v32, v33
    v_cvt_pk_bf16_f32 v65, v34, v35
    v_cvt_pk_bf16_f32 v66, v36, v37
    v_cvt_pk_bf16_f32 v67, v38, v39
    v_exp_f32 v40, v40
    v_exp_f32 v41, v41
    v_smfmac_f32_16x16x64_bf16 v[96:99], v[116:119], v[72:79], v120
    s_waitcnt lgkmcnt(1)
    v_exp_f32 v42, v42
    v_exp_f32 v43, v43
    v_exp_f32 v44, v44
    v_exp_f32 v45, v45
    v_mfma_f32_32x32x16_bf16 v[80:95], v[108:111], v[64:67], v[80:95]
    ds_read_b128 v[108:111], v2 offset:14336
    s_add_u32 m0, s98, 32768
    s_add_u32 s0, s55, 16384
    buffer_load_dwordx4 v2, s[84:87], s55 offen offset:1024 sc1 lds
    v_exp_f32 v46, v46
    v_exp_f32 v47, v47
    s_setprio 2
    v_cvt_pk_bf16_f32 v68, v40, v41
    v_cvt_pk_bf16_f32 v69, v42, v43
    v_cvt_pk_bf16_f32 v70, v44, v45
    v_cvt_pk_bf16_f32 v71, v46, v47
    v_mfma_f32_32x32x16_bf16 v[32:47], v[100:103], v[8:11], v[16:31]
    ds_read_b128 v[100:103], v2 offset:20480
    v_exp_f32 v48, v48
    v_exp_f32 v49, v49
    v_exp_f32 v50, v50
    v_exp_f32 v51, v51
    v_mfma_f32_32x32x16_bf16 v[32:47], v[104:107], v[12:15], v[32:47]
    ds_read_b128 v[104:107], v2 offset:21504
    s_add_u32 m0, s98, 49152
    s_and_b32 s55, s0, 0x3ffff
    buffer_load_dwordx4 v2, s[84:87], s55 offen offset:0 sc1 lds
    v_exp_f32 v52, v52
    v_exp_f32 v53, v53
    v_exp_f32 v54, v54
    v_exp_f32 v55, v55
    s_waitcnt lgkmcnt(3)
    v_mfma_f32_32x32x16_bf16 v[80:95], v[112:115], v[68:71], v[80:95]
    ds_read_b128 v[112:115], v2 offset:15360
    s_add_u32 m0, s98, 49152
    s_add_u32 s0, s55, 16384
    buffer_load_dwordx4 v2, s[84:87], s55 offen offset:1024 sc1 lds
    v_cvt_pk_bf16_f32 v72, v48, v49
    v_cvt_pk_bf16_f32 v73, v50, v51
    v_cvt_pk_bf16_f32 v74, v52, v53
    v_cvt_pk_bf16_f32 v75, v54, v55
    v_exp_f32 v56, v56
    v_exp_f32 v57, v57
    v_smfmac_f32_16x16x64_bf16 v[96:99], v[116:119], v[64:71], v120
    s_waitcnt lgkmcnt(1)
    v_exp_f32 v58, v58
    v_exp_f32 v59, v59
    v_exp_f32 v60, v60
    v_exp_f32 v61, v61
    v_mfma_f32_32x32x16_bf16 v[80:95], v[108:111], v[72:75], v[80:95]
    ds_read_b128 v[108:111], v2 offset:18432
    s_lshl1_add_u32 m0, s98, 65536
    s_add_u32 s10, s92, 0
    buffer_load_dwordx4 v122, s[64:67], s10 offen lds
    v_exp_f32 v62, v62
    v_exp_f32 v63, v63
    s_setprio 1
    v_cvt_pk_bf16_f32 v76, v56, v57
    v_cvt_pk_bf16_f32 v77, v58, v59
    v_cvt_pk_bf16_f32 v78, v60, v61
    v_cvt_pk_bf16_f32 v79, v62, v63
    v_mfma_f32_32x32x16_bf16 v[48:63], v[100:103], v[8:11], v[16:31]
    ds_read_b128 v[100:103], v2 offset:24576
    v_exp_f32 v32, v32
    v_exp_f32 v33, v33
    v_exp_f32 v34, v34
    v_exp_f32 v35, v35
    v_mfma_f32_32x32x16_bf16 v[48:63], v[104:107], v[12:15], v[48:63]
    ds_read_b128 v[104:107], v2 offset:25600
    v_exp_f32 v36, v36
    v_exp_f32 v37, v37
    v_exp_f32 v38, v38
    v_exp_f32 v39, v39
    s_waitcnt lgkmcnt(3)
    v_mfma_f32_32x32x16_bf16 v[80:95], v[112:115], v[76:79], v[80:95]
    ds_read_b128 v[112:115], v2 offset:19456
    s_lshl1_add_u32 m0, s98, 66560
    s_add_u32 s10, s92, 57344
    buffer_load_dwordx4 v126, s[64:67], s10 offen lds
    v_cvt_pk_bf16_f32 v64, v32, v33
    v_cvt_pk_bf16_f32 v65, v34, v35
    v_cvt_pk_bf16_f32 v66, v36, v37
    v_cvt_pk_bf16_f32 v67, v38, v39
    v_exp_f32 v40, v40
    v_exp_f32 v41, v41
    v_smfmac_f32_16x16x64_bf16 v[96:99], v[116:119], v[72:79], v120
    s_waitcnt lgkmcnt(1)
    v_exp_f32 v42, v42
    v_exp_f32 v43, v43
    v_exp_f32 v44, v44
    v_exp_f32 v45, v45
    v_mfma_f32_32x32x16_bf16 v[80:95], v[108:111], v[64:67], v[80:95]
    ds_read_b128 v[108:111], v2 offset:22528
    v_exp_f32 v46, v46
    v_exp_f32 v47, v47
    s_setprio 0
    v_cvt_pk_bf16_f32 v68, v40, v41
    v_cvt_pk_bf16_f32 v69, v42, v43
    v_cvt_pk_bf16_f32 v70, v44, v45
    v_cvt_pk_bf16_f32 v71, v46, v47
    v_mfma_f32_32x32x16_bf16 v[32:47], v[100:103], v[8:11], v[16:31]
    ds_read_b128 v[100:103], v2 offset:28672
    v_exp_f32 v48, v48
    v_exp_f32 v49, v49
    v_exp_f32 v50, v50
    v_exp_f32 v51, v51
    v_mfma_f32_32x32x16_bf16 v[32:47], v[104:107], v[12:15], v[32:47]
    ds_read_b128 v[104:107], v2 offset:29696
    s_lshl1_add_u32 m0, s98, 67584
    s_add_u32 s10, s92, 114688
    buffer_load_dwordx4 v122, s[64:67], s10 offen lds
    v_exp_f32 v52, v52
    v_exp_f32 v53, v53
    v_exp_f32 v54, v54
    v_exp_f32 v55, v55
    s_waitcnt lgkmcnt(3)
    v_mfma_f32_32x32x16_bf16 v[80:95], v[112:115], v[68:71], v[80:95]
    ds_read_b128 v[112:115], v2 offset:23552
    v_cvt_pk_bf16_f32 v72, v48, v49
    v_cvt_pk_bf16_f32 v73, v50, v51
    v_cvt_pk_bf16_f32 v74, v52, v53
    v_cvt_pk_bf16_f32 v75, v54, v55
    v_exp_f32 v56, v56
    v_exp_f32 v57, v57
    v_smfmac_f32_16x16x64_bf16 v[96:99], v[116:119], v[64:71], v120
    s_waitcnt lgkmcnt(1)
    v_exp_f32 v58, v58
    v_exp_f32 v59, v59
    v_exp_f32 v60, v60
    v_exp_f32 v61, v61
    v_mfma_f32_32x32x16_bf16 v[80:95], v[108:111], v[72:75], v[80:95]
    ds_read_b128 v[108:111], v2 offset:26624
    s_cmp_eq_u32 s3, 1
    s_cbranch_scc0 L_rx_96
    s_waitcnt vmcnt(7)
    v_mov_b32 v123, v192
    s_nop 1
    v_max_u32_dpp v123, v123, v123 row_shr:1 row_mask:0xf bank_mask:0xf
    s_nop 1
    v_max_u32_dpp v123, v123, v123 row_shr:2 row_mask:0xf bank_mask:0xf
    s_nop 1
    v_max_u32_dpp v123, v123, v123 row_shr:4 row_mask:0xf bank_mask:0xf
    s_nop 1
    v_max_u32_dpp v123, v123, v123 row_shr:8 row_mask:0xf bank_mask:0xf
    s_nop 1
    v_max_u32_dpp v123, v123, v123 row_bcast:15 row_mask:0xa bank_mask:0xf
    s_nop 1
    v_max_u32_dpp v123, v123, v123 row_bcast:31 row_mask:0xc bank_mask:0xf
    s_nop 0
    v_readlane_b32 s12, v123, 63
    v_mov_b32 v123, 149504
    s_nop 0
    v_cmp_eq_u32 vcc, s12, v192
    s_nop 0
    s_mov_b64 exec, vcc
    ds_write_b128 v123, v[192:195]
    s_mov_b64 exec, -1
    s_waitcnt lgkmcnt(0)
L_rx_96:
    v_exp_f32 v62, v62
    v_exp_f32 v63, v63
    s_setprio 3
    v_cvt_pk_bf16_f32 v76, v56, v57
    v_cvt_pk_bf16_f32 v77, v58, v59
    v_cvt_pk_bf16_f32 v78, v60, v61
    v_cvt_pk_bf16_f32 v79, v62, v63
    v_mfma_f32_32x32x16_bf16 v[48:63], v[100:103], v[8:11], v[16:31]
    s_waitcnt vmcnt(5)
    s_barrier
    ds_read_b128 v[100:103], v2 offset:32768
    v_exp_f32 v32, v32
    v_exp_f32 v33, v33
    v_exp_f32 v34, v34
    v_exp_f32 v35, v35
    v_mfma_f32_32x32x16_bf16 v[48:63], v[104:107], v[12:15], v[48:63]
    ds_read_b128 v[104:107], v2 offset:33792
    v_mov_b32 v123, 149504
    ds_read_b128 v[192:195], v123
    v_exp_f32 v36, v36
    v_exp_f32 v37, v37
    v_exp_f32 v38, v38
    v_exp_f32 v39, v39
    s_waitcnt lgkmcnt(4)
    v_mfma_f32_32x32x16_bf16 v[80:95], v[112:115], v[76:79], v[80:95]
    ds_read_b128 v[112:115], v2 offset:27648
    s_add_u32 m0, s98, 0
    s_and_b32 s55, s0, 0x3ffff
    buffer_load_dwordx4 v2, s[84:87], s55 offen offset:0 sc1 lds
    v_cvt_pk_bf16_f32 v64, v32, v33
    v_cvt_pk_bf16_f32 v65, v34, v35
    v_cvt_pk_bf16_f32 v66, v36, v37
    v_cvt_pk_bf16_f32 v67, v38, v39
    v_exp_f32 v40, v40
    v_exp_f32 v41, v41
    v_smfmac_f32_16x16x64_bf16 v[96:99], v[116:119], v[72:79], v120
    s_waitcnt lgkmcnt(2)
    v_exp_f32 v42, v42
    v_exp_f32 v43, v43
    v_exp_f32 v44, v44
    v_exp_f32 v45, v45
    v_mfma_f32_32x32x16_bf16 v[80:95], v[108:111], v[64:67], v[80:95]
    ds_read_b128 v[108:111], v2 offset:30720
    s_add_u32 m0, s98, 0
    s_add_u32 s0, s55, 16384
    buffer_load_dwordx4 v2, s[84:87], s55 offen offset:1024 sc1 lds
    v_exp_f32 v46, v46
    v_exp_f32 v47, v47
    s_setprio 2
    v_cvt_pk_bf16_f32 v68, v40, v41
    v_cvt_pk_bf16_f32 v69, v42, v43
    v_cvt_pk_bf16_f32 v70, v44, v45
    v_cvt_pk_bf16_f32 v71, v46, v47
    v_mfma_f32_32x32x16_bf16 v[32:47], v[100:103], v[8:11], v[16:31]
    ds_read_b128 v[100:103], v2 offset:36864
    v_exp_f32 v48, v48
    v_exp_f32 v49, v49
    v_exp_f32 v50, v50
    v_exp_f32 v51, v51
    v_mfma_f32_32x32x16_bf16 v[32:47], v[104:107], v[12:15], v[32:47]
    ds_read_b128 v[104:107], v2 offset:37888
    s_waitcnt lgkmcnt(4)
    v_readfirstlane_b32 s88, v192
    v_readfirstlane_b32 s96, v193
    s_and_b32 s88, s88, 0xffff
    s_sub_u32 s88, 2047, s88
    s_and_b32 s88, s88, 2047
    s_lshr_b32 s10, s88, 6
    s_cmp_eq_u32 s10, s4
    s_cselect_b32 s89, 1, 0
    s_lshl_b32 s10, s88, 11
    buffer_load_dword v196, v181, s[44:47], s10 offen
    v_exp_f32 v52, v52
    v_exp_f32 v53, v53
    v_exp_f32 v54, v54
    v_exp_f32 v55, v55
    s_waitcnt lgkmcnt(3)
    v_mfma_f32_32x32x16_bf16 v[80:95], v[112:115], v[68:71], v[80:95]
    ds_read_b128 v[112:115], v2 offset:31744
    s_lshl1_add_u32 m0, s98, 68608
    s_add_u32 s10, s92, 172032
    buffer_load_dwordx4 v126, s[64:67], s10 offen lds
    v_cvt_pk_bf16_f32 v72, v48, v49
    v_cvt_pk_bf16_f32 v73, v50, v51
    v_cvt_pk_bf16_f32 v74, v52, v53
    v_cvt_pk_bf16_f32 v75, v54, v55
    v_exp_f32 v56, v56
    v_exp_f32 v57, v57
    v_smfmac_f32_16x16x64_bf16 v[96:99], v[116:119], v[64:71], v120
    s_waitcnt lgkmcnt(1)
    v_exp_f32 v58, v58
    v_exp_f32 v59, v59
    v_exp_f32 v60, v60
    v_exp_f32 v61, v61
    v_mfma_f32_32x32x16_bf16 v[80:95], v[108:111], v[72:75], v[80:95]
    ds_read_b128 v[108:111], v2 offset:34816
    v_exp_f32 v62, v62
    v_exp_f32 v63, v63
    s_setprio 1
    v_cvt_pk_bf16_f32 v76, v56, v57
    v_cvt_pk_bf16_f32 v77, v58, v59
    v_cvt_pk_bf16_f32 v78, v60, v61
    v_cvt_pk_bf16_f32 v79, v62, v63
    v_mfma_f32_32x32x16_bf16 v[48:63], v[100:103], v[8:11], v[16:31]
    ds_read_b128 v[100:103], v2 offset:40960
    v_exp_f32 v32, v32
    v_exp_f32 v33, v33
    v_exp_f32 v34, v34
    v_exp_f32 v35, v35
    v_mfma_f32_32x32x16_bf16 v[48:63], v[104:107], v[12:15], v[48:63]
    ds_read_b128 v[104:107], v2 offset:41984
    s_lshl1_add_u32 m0, s98, 98304
    s_add_u32 s10, s92, 0
    buffer_load_dwordx4 v122, s[68:71], s10 offen lds
    v_exp_f32 v36, v36
    v_exp_f32 v37, v37
    v_exp_f32 v38, v38
    v_exp_f32 v39, v39
    s_waitcnt lgkmcnt(3)
    v_mfma_f32_32x32x16_bf16 v[80:95], v[112:115], v[76:79], v[80:95]
    ds_read_b128 v[112:115], v2 offset:35840
    v_cvt_pk_bf16_f32 v64, v32, v33
    v_cvt_pk_bf16_f32 v65, v34, v35
    v_cvt_pk_bf16_f32 v66, v36, v37
    v_cvt_pk_bf16_f32 v67, v38, v39
    v_exp_f32 v40, v40
    v_exp_f32 v41, v41
    v_smfmac_f32_16x16x64_bf16 v[96:99], v[116:119], v[72:79], v120
    s_waitcnt lgkmcnt(1)
    v_exp_f32 v42, v42
    v_exp_f32 v43, v43
    v_exp_f32 v44, v44
    v_exp_f32 v45, v45
    v_mfma_f32_32x32x16_bf16 v[80:95], v[108:111], v[64:67], v[80:95]
    ds_read_b128 v[108:111], v2 offset:38912
    s_lshl1_add_u32 m0, s98, 99328
    s_add_u32 s10, s92, 57344
    buffer_load_dwordx4 v126, s[68:71], s10 offen lds
    v_exp_f32 v46, v46
    v_exp_f32 v47, v47
    s_setprio 0
    v_cvt_pk_bf16_f32 v68, v40, v41
    v_cvt_pk_bf16_f32 v69, v42, v43
    v_cvt_pk_bf16_f32 v70, v44, v45
    v_cvt_pk_bf16_f32 v71, v46, v47
    v_mfma_f32_32x32x16_bf16 v[32:47], v[100:103], v[8:11], v[16:31]
    ds_read_b128 v[100:103], v2 offset:45056
    v_exp_f32 v48, v48
    v_exp_f32 v49, v49
    v_exp_f32 v50, v50
    v_exp_f32 v51, v51
    v_mfma_f32_32x32x16_bf16 v[32:47], v[104:107], v[12:15], v[32:47]
    ds_read_b128 v[104:107], v2 offset:46080
    v_exp_f32 v52, v52
    v_exp_f32 v53, v53
    v_exp_f32 v54, v54
    v_exp_f32 v55, v55
    s_waitcnt lgkmcnt(3)
    v_mfma_f32_32x32x16_bf16 v[80:95], v[112:115], v[68:71], v[80:95]
    ds_read_b128 v[112:115], v2 offset:39936
    s_lshl1_add_u32 m0, s98, 100352
    s_add_u32 s10, s92, 114688
    buffer_load_dwordx4 v122, s[68:71], s10 offen lds
    v_cvt_pk_bf16_f32 v72, v48, v49
    v_cvt_pk_bf16_f32 v73, v50, v51
    v_cvt_pk_bf16_f32 v74, v52, v53
    v_cvt_pk_bf16_f32 v75, v54, v55
    v_exp_f32 v56, v56
    v_exp_f32 v57, v57
    v_smfmac_f32_16x16x64_bf16 v[96:99], v[116:119], v[64:71], v120
    s_waitcnt lgkmcnt(1)
    v_exp_f32 v58, v58
    v_exp_f32 v59, v59
    v_exp_f32 v60, v60
    v_exp_f32 v61, v61
    v_mfma_f32_32x32x16_bf16 v[80:95], v[108:111], v[72:75], v[80:95]
    ds_read_b128 v[108:111], v2 offset:43008
    v_exp_f32 v62, v62
    v_exp_f32 v63, v63
    s_setprio 3
    v_cvt_pk_bf16_f32 v76, v56, v57
    v_cvt_pk_bf16_f32 v77, v58, v59
    v_cvt_pk_bf16_f32 v78, v60, v61
    v_cvt_pk_bf16_f32 v79, v62, v63
    v_mfma_f32_32x32x16_bf16 v[48:63], v[100:103], v[8:11], v[16:31]
    s_waitcnt vmcnt(10)
    s_barrier
    ds_read_b128 v[100:103], v2 offset:49152
    v_exp_f32 v32, v32
    v_exp_f32 v33, v33
    v_exp_f32 v34, v34
    v_exp_f32 v35, v35
    v_mfma_f32_32x32x16_bf16 v[48:63], v[104:107], v[12:15], v[48:63]
    ds_read_b128 v[104:107], v2 offset:50176
    s_add_u32 m0, s98, 16384
    s_and_b32 s55, s0, 0x3ffff
    buffer_load_dwordx4 v2, s[84:87], s55 offen offset:0 sc1 lds
    v_exp_f32 v36, v36
    v_exp_f32 v37, v37
    v_exp_f32 v38, v38
    v_exp_f32 v39, v39
    s_waitcnt lgkmcnt(3)
    v_mfma_f32_32x32x16_bf16 v[80:95], v[112:115], v[76:79], v[80:95]
    ds_read_b128 v[112:115], v2 offset:44032
    s_add_u32 m0, s98, 16384
    s_add_u32 s0, s55, 16384
    buffer_load_dwordx4 v2, s[84:87], s55 offen offset:1024 sc1 lds
    v_cvt_pk_bf16_f32 v64, v32, v33
    v_cvt_pk_bf16_f32 v65, v34, v35
    v_cvt_pk_bf16_f32 v66, v36, v37
    v_cvt_pk_bf16_f32 v67, v38, v39
    v_exp_f32 v40, v40
    v_exp_f32 v41, v41
    v_smfmac_f32_16x16x64_bf16 v[96:99], v[116:119], v[72:79], v120
    s_waitcnt lgkmcnt(1)
    v_exp_f32 v42, v42
    v_exp_f32 v43, v43
    v_exp_f32 v44, v44
    v_exp_f32 v45, v45
    v_mfma_f32_32x32x16_bf16 v[80:95], v[108:111], v[64:67], v[80:95]
    ds_read_b128 v[108:111], v2 offset:47104
    s_lshl1_add_u32 m0, s98, 101376
    s_add_u32 s10, s92, 172032
    buffer_load_dwordx4 v126, s[68:71], s10 offen lds
    v_exp_f32 v46, v46
    v_exp_f32 v47, v47
    s_setprio 2
    v_cvt_pk_bf16_f32 v68, v40, v41
    v_cvt_pk_bf16_f32 v69, v42, v43
    v_cvt_pk_bf16_f32 v70, v44, v45
    v_cvt_pk_bf16_f32 v71, v46, v47
    v_mfma_f32_32x32x16_bf16 v[32:47], v[100:103], v[8:11], v[16:31]
    ds_read_b128 v[100:103], v2 offset:53248
    v_exp_f32 v48, v48
    v_exp_f32 v49, v49
    v_exp_f32 v50, v50
    v_exp_f32 v51, v51
    v_mfma_f32_32x32x16_bf16 v[32:47], v[104:107], v[12:15], v[32:47]
    ds_read_b128 v[104:107], v2 offset:54272
    v_exp_f32 v52, v52
    v_exp_f32 v53, v53
    v_exp_f32 v54, v54
    v_exp_f32 v55, v55
    s_waitcnt lgkmcnt(3)
    v_mfma_f32_32x32x16_bf16 v[80:95], v[112:115], v[68:71], v[80:95]
    ds_read_b128 v[112:115], v2 offset:48128
    s_add_u32 m0, s98, 131072
    s_add_u32 s10, s93, 0
    buffer_load_dwordx4 v127, s[72:75], s10 offen lds
    v_cvt_pk_bf16_f32 v72, v48, v49
    v_cvt_pk_bf16_f32 v73, v50, v51
    v_cvt_pk_bf16_f32 v74, v52, v53
    v_cvt_pk_bf16_f32 v75, v54, v55
    v_exp_f32 v56, v56
    v_exp_f32 v57, v57
    v_smfmac_f32_16x16x64_bf16 v[96:99], v[116:119], v[64:71], v120
    s_waitcnt lgkmcnt(1)
    v_exp_f32 v58, v58
    v_exp_f32 v59, v59
    v_exp_f32 v60, v60
    v_exp_f32 v61, v61
    v_mfma_f32_32x32x16_bf16 v[80:95], v[108:111], v[72:75], v[80:95]
    ds_read_b128 v[108:111], v2 offset:51200
    v_exp_f32 v62, v62
    v_exp_f32 v63, v63
    s_setprio 1
    v_cvt_pk_bf16_f32 v76, v56, v57
    v_cvt_pk_bf16_f32 v77, v58, v59
    v_cvt_pk_bf16_f32 v78, v60, v61
    v_cvt_pk_bf16_f32 v79, v62, v63
    v_mfma_f32_32x32x16_bf16 v[48:63], v[100:103], v[8:11], v[16:31]
    ds_read_b128 v[100:103], v2 offset:57344
    v_exp_f32 v32, v32
    v_exp_f32 v33, v33
    v_exp_f32 v34, v34
    v_exp_f32 v35, v35
    v_mfma_f32_32x32x16_bf16 v[48:63], v[104:107], v[12:15], v[48:63]
    ds_read_b128 v[104:107], v2 offset:58368
    s_add_u32 m0, s98, 132096
    s_add_u32 s10, s93, 32768
    buffer_load_dwordx4 v127, s[72:75], s10 offen lds
    v_exp_f32 v36, v36
    v_exp_f32 v37, v37
    v_exp_f32 v38, v38
    v_exp_f32 v39, v39
    s_waitcnt lgkmcnt(3)
    v_mfma_f32_32x32x16_bf16 v[80:95], v[112:115], v[76:79], v[80:95]
    ds_read_b128 v[112:115], v2 offset:52224
    v_cvt_pk_bf16_f32 v64, v32, v33
    v_cvt_pk_bf16_f32 v65, v34, v35
    v_cvt_pk_bf16_f32 v66, v36, v37
    v_cvt_pk_bf16_f32 v67, v38, v39
    v_exp_f32 v40, v40
    v_exp_f32 v41, v41
    v_smfmac_f32_16x16x64_bf16 v[96:99], v[116:119], v[72:79], v120
    s_waitcnt lgkmcnt(1)
    v_exp_f32 v42, v42
    v_exp_f32 v43, v43
    v_exp_f32 v44, v44
    v_exp_f32 v45, v45
    v_mfma_f32_32x32x16_bf16 v[80:95], v[108:111], v[64:67], v[80:95]
    ds_read_b128 v[108:111], v2 offset:55296
    v_exp_f32 v46, v46
    v_exp_f32 v47, v47
    s_setprio 0
    v_cvt_pk_bf16_f32 v68, v40, v41
    v_cvt_pk_bf16_f32 v69, v42, v43
    v_cvt_pk_bf16_f32 v70, v44, v45
    v_cvt_pk_bf16_f32 v71, v46, v47
    v_mfma_f32_32x32x16_bf16 v[32:47], v[100:103], v[8:11], v[16:31]
    ds_read_b128 v[100:103], v2 offset:61440
    v_exp_f32 v48, v48
    v_exp_f32 v49, v49
    v_exp_f32 v50, v50
    v_exp_f32 v51, v51
    v_mfma_f32_32x32x16_bf16 v[32:47], v[104:107], v[12:15], v[32:47]
    ds_read_b128 v[104:107], v2 offset:62464
    s_waitcnt vmcnt(9)
    v_lshlrev_b32 v197, 16, v196
    v_and_b32 v198, 0xffff0000, v196
    v_sub_f32 v197, v197, v194
    v_sub_f32 v198, v198, v194
    v_cvt_pk_bf16_f32 v196, v197, v198
    v_lshlrev_b32 v197, 16, v196
    v_and_b32 v198, 0xffff0000, v196
    v_mul_f32 v197, v197, v195
    v_mul_f32 v198, v198, v195
    v_cvt_pk_bf16_f32 v196, v197, v198
    v_add_u32 v123, 147456, v181
    ds_write_b32 v123, v196
    v_exp_f32 v52, v52
    v_exp_f32 v53, v53
    v_exp_f32 v54, v54
    v_exp_f32 v55, v55
    s_waitcnt lgkmcnt(4)
    v_mfma_f32_32x32x16_bf16 v[80:95], v[112:115], v[68:71], v[80:95]
    ds_read_b128 v[112:115], v2 offset:56320
    v_cvt_pk_bf16_f32 v72, v48, v49
    v_cvt_pk_bf16_f32 v73, v50, v51
    v_cvt_pk_bf16_f32 v74, v52, v53
    v_cvt_pk_bf16_f32 v75, v54, v55
    v_exp_f32 v56, v56
    v_exp_f32 v57, v57
    v_smfmac_f32_16x16x64_bf16 v[96:99], v[116:119], v[64:71], v120
    s_waitcnt lgkmcnt(2)
    v_exp_f32 v58, v58
    v_exp_f32 v59, v59
    v_exp_f32 v60, v60
    v_exp_f32 v61, v61
    v_mfma_f32_32x32x16_bf16 v[80:95], v[108:111], v[72:75], v[80:95]
    ds_read_b128 v[108:111], v2 offset:59392
    v_exp_f32 v62, v62
    v_exp_f32 v63, v63
    s_setprio 3
    v_cvt_pk_bf16_f32 v76, v56, v57
    v_cvt_pk_bf16_f32 v77, v58, v59
    v_cvt_pk_bf16_f32 v78, v60, v61
    v_cvt_pk_bf16_f32 v79, v62, v63
    v_mfma_f32_32x32x16_bf16 v[48:63], v[100:103], v[8:11], v[16:31]
    s_waitcnt lgkmcnt(2)
    s_waitcnt vmcnt(10)
    s_barrier
    ds_read_b128 v[100:103], v2 offset:0
    v_exp_f32 v32, v32
    v_exp_f32 v33, v33
    v_exp_f32 v34, v34
    v_exp_f32 v35, v35
    v_mfma_f32_32x32x16_bf16 v[48:63], v[104:107], v[12:15], v[48:63]
    ds_read_b128 v[104:107], v2 offset:1024
    ds_read_b128 v[184:187], v179
    v_exp_f32 v36, v36
    v_exp_f32 v37, v37
    v_exp_f32 v38, v38
    v_exp_f32 v39, v39
    s_waitcnt lgkmcnt(4)
    v_mfma_f32_32x32x16_bf16 v[80:95], v[112:115], v[76:79], v[80:95]
    ds_read_b128 v[112:115], v2 offset:60416
    s_add_u32 m0, s98, 32768
    s_and_b32 s55, s0, 0x3ffff
    buffer_load_dwordx4 v2, s[84:87], s55 offen offset:0 sc1 lds
    v_cvt_pk_bf16_f32 v64, v32, v33
    v_cvt_pk_bf16_f32 v65, v34, v35
    v_cvt_pk_bf16_f32 v66, v36, v37
    v_cvt_pk_bf16_f32 v67, v38, v39
    v_exp_f32 v40, v40
    v_exp_f32 v41, v41
    v_smfmac_f32_16x16x64_bf16 v[96:99], v[116:119], v[72:79], v120
    s_waitcnt lgkmcnt(2)
    v_exp_f32 v42, v42
    v_exp_f32 v43, v43
    v_exp_f32 v44, v44
    v_exp_f32 v45, v45
    v_mfma_f32_32x32x16_bf16 v[80:95], v[108:111], v[64:67], v[80:95]
    ds_read_b128 v[108:111], v2 offset:63488
    s_add_u32 m0, s98, 32768
    s_add_u32 s0, s55, 16384
    buffer_load_dwordx4 v2, s[84:87], s55 offen offset:1024 sc1 lds
    v_exp_f32 v46, v46
    v_exp_f32 v47, v47
    s_setprio 2
    v_cvt_pk_bf16_f32 v68, v40, v41
    v_cvt_pk_bf16_f32 v69, v42, v43
    v_cvt_pk_bf16_f32 v70, v44, v45
    v_cvt_pk_bf16_f32 v71, v46, v47
    v_mfma_f32_32x32x16_bf16 v[32:47], v[100:103], v[8:11], v[16:31]
    ds_read_b128 v[100:103], v2 offset:4096
    v_exp_f32 v48, v48
    v_exp_f32 v49, v49
    v_exp_f32 v50, v50
    v_exp_f32 v51, v51
    v_mfma_f32_32x32x16_bf16 v[32:47], v[104:107], v[12:15], v[32:47]
    ds_read_b128 v[104:107], v2 offset:5120
    s_lshl_b32 s10, s91, 12
    s_lshl_b32 s11, s90, 10
    s_add_u32 s10, s10, s11
    s_lshl_b32 s26, s5, 14
    s_add_u32 s26, s26, s95
    s_add_u32 s26, s26, s10
    s_add_u32 s26, s26, 2097152
    v_mov_b32 v204, -1
    v_mov_b32 v205, -1
    v_mov_b32 v206, -1
    v_mov_b32 v207, -1
    buffer_store_dwordx4 v[204:207], v2, s[84:87], s26 offen offset:0 sc1
    v_exp_f32 v52, v52
    v_exp_f32 v53, v53
    v_exp_f32 v54, v54
    v_exp_f32 v55, v55
    s_waitcnt lgkmcnt(3)
    v_mfma_f32_32x32x16_bf16 v[80:95], v[112:115], v[68:71], v[80:95]
    ds_read_b128 v[112:115], v2 offset:64512
    v_cvt_pk_bf16_f32 v72, v48, v49
    v_cvt_pk_bf16_f32 v73, v50, v51
    v_cvt_pk_bf16_f32 v74, v52, v53
    v_cvt_pk_bf16_f32 v75, v54, v55
    v_exp_f32 v56, v56
    v_exp_f32 v57, v57
    v_smfmac_f32_16x16x64_bf16 v[96:99], v[116:119], v[64:71], v120
    s_waitcnt lgkmcnt(1)
    v_exp_f32 v58, v58
    v_exp_f32 v59, v59
    v_exp_f32 v60, v60
    v_exp_f32 v61, v61
    v_mfma_f32_32x32x16_bf16 v[80:95], v[108:111], v[72:75], v[80:95]
    ds_read_b128 v[108:111], v2 offset:2048
    buffer_store_dwordx4 v[204:207], v2, s[84:87], s26 offen offset:2048 sc1
    v_exp_f32 v62, v62
    v_exp_f32 v63, v63
    s_setprio 1
    v_cvt_pk_bf16_f32 v76, v56, v57
    v_cvt_pk_bf16_f32 v77, v58, v59
    v_cvt_pk_bf16_f32 v78, v60, v61
    v_cvt_pk_bf16_f32 v79, v62, v63
    v_mfma_f32_32x32x16_bf16 v[48:63], v[100:103], v[8:11], v[16:31]
    ds_read_b128 v[100:103], v2 offset:8192
    v_exp_f32 v32, v32
    v_exp_f32 v33, v33
    v_exp_f32 v34, v34
    v_exp_f32 v35, v35
    v_mfma_f32_32x32x16_bf16 v[48:63], v[104:107], v[12:15], v[48:63]
    ds_read_b128 v[104:107], v2 offset:9216
    v_exp_f32 v36, v36
    v_exp_f32 v37, v37
    v_exp_f32 v38, v38
    v_exp_f32 v39, v39
    s_waitcnt lgkmcnt(3)
    v_mfma_f32_32x32x16_bf16 v[80:95], v[112:115], v[76:79], v[80:95]
    ds_read_b128 v[112:115], v2 offset:3072
    s_waitcnt vmcnt(6)
    ds_read_b64_tr_b16 v[224:225], v176 offset:0
    ds_read_b64_tr_b16 v[226:227], v176 offset:512
    ds_read_b64_tr_b16 v[240:241], v176 offset:32768
    ds_read_b64_tr_b16 v[242:243], v176 offset:33280
    v_cvt_pk_bf16_f32 v64, v32, v33
    v_cvt_pk_bf16_f32 v65, v34, v35
    v_cvt_pk_bf16_f32 v66, v36, v37
    v_cvt_pk_bf16_f32 v67, v38, v39
    v_exp_f32 v40, v40
    v_exp_f32 v41, v41
    v_smfmac_f32_16x16x64_bf16 v[96:99], v[116:119], v[72:79], v120
    s_waitcnt lgkmcnt(5)
    v_exp_f32 v42, v42
    v_exp_f32 v43, v43
    v_exp_f32 v44, v44
    v_exp_f32 v45, v45
    v_mfma_f32_32x32x16_bf16 v[80:95], v[108:111], v[64:67], v[80:95]
    ds_read_b128 v[108:111], v2 offset:6144
    v_xor_b32 v123, 32, v176
    ds_read_b64_tr_b16 v[228:229], v123 offset:0
    ds_read_b64_tr_b16 v[230:231], v123 offset:512
    ds_read_b64_tr_b16 v[244:245], v123 offset:32768
    ds_read_b64_tr_b16 v[246:247], v123 offset:33280
    v_exp_f32 v46, v46
    v_exp_f32 v47, v47
    s_setprio 0
    v_cvt_pk_bf16_f32 v68, v40, v41
    v_cvt_pk_bf16_f32 v69, v42, v43
    v_cvt_pk_bf16_f32 v70, v44, v45
    v_cvt_pk_bf16_f32 v71, v46, v47
    v_mfma_f32_32x32x16_bf16 v[32:47], v[100:103], v[8:11], v[16:31]
    ds_read_b128 v[100:103], v2 offset:12288
    v_exp_f32 v48, v48
    v_exp_f32 v49, v49
    v_exp_f32 v50, v50
    v_exp_f32 v51, v51
    v_mfma_f32_32x32x16_bf16 v[32:47], v[104:107], v[12:15], v[32:47]
    ds_read_b128 v[104:107], v2 offset:13312
    v_xor_b32 v123, 64, v176
    ds_read_b64_tr_b16 v[232:233], v123 offset:0
    ds_read_b64_tr_b16 v[234:235], v123 offset:512
    ds_read_b64_tr_b16 v[248:249], v123 offset:32768
    ds_read_b64_tr_b16 v[250:251], v123 offset:33280
    v_exp_f32 v52, v52
    v_exp_f32 v53, v53
    v_exp_f32 v54, v54
    v_exp_f32 v55, v55
    s_waitcnt lgkmcnt(15)
    v_mfma_f32_32x32x16_bf16 v[80:95], v[112:115], v[68:71], v[80:95]
    ds_read_b128 v[112:115], v2 offset:7168
    v_xor_b32 v123, 96, v176
    ds_read_b64_tr_b16 v[236:237], v123 offset:0
    ds_read_b64_tr_b16 v[238:239], v123 offset:512
    ds_read_b64_tr_b16 v[252:253], v123 offset:32768
    ds_read_b64_tr_b16 v[254:255], v123 offset:33280
    v_cvt_pk_bf16_f32 v72, v48, v49
    v_cvt_pk_bf16_f32 v73, v50, v51
    v_cvt_pk_bf16_f32 v74, v52, v53
    v_cvt_pk_bf16_f32 v75, v54, v55
    v_exp_f32 v56, v56
    v_exp_f32 v57, v57
    v_smfmac_f32_16x16x64_bf16 v[96:99], v[116:119], v[64:71], v120
    s_waitcnt lgkmcnt(9)
    v_exp_f32 v58, v58
    v_exp_f32 v59, v59
    v_exp_f32 v60, v60
    v_exp_f32 v61, v61
    v_mfma_f32_32x32x16_bf16 v[80:95], v[108:111], v[72:75], v[80:95]
    ds_read_b128 v[108:111], v2 offset:10240
    v_exp_f32 v62, v62
    v_exp_f32 v63, v63
    s_setprio 3
    v_cvt_pk_bf16_f32 v76, v56, v57
    v_cvt_pk_bf16_f32 v77, v58, v59
    v_cvt_pk_bf16_f32 v78, v60, v61
    v_cvt_pk_bf16_f32 v79, v62, v63
    v_mfma_f32_32x32x16_bf16 v[48:63], v[100:103], v[8:11], v[16:31]
    s_waitcnt lgkmcnt(1)
    s_waitcnt vmcnt(7)
    s_barrier
    ds_read_b128 v[100:103], v2 offset:16384
    v_exp_f32 v32, v32
    v_exp_f32 v33, v33
    v_exp_f32 v34, v34
    v_exp_f32 v35, v35
    v_mfma_f32_32x32x16_bf16 v[48:63], v[104:107], v[12:15], v[48:63]
    ds_read_b128 v[104:107], v2 offset:17408
    v_mfma_f32_16x16x32_bf16 v[192:195], v[184:187], v[224:227], 0
    v_mfma_f32_16x16x32_bf16 v[196:199], v[184:187], v[228:231], 0
    v_exp_f32 v36, v36
    v_exp_f32 v37, v37
    v_exp_f32 v38, v38
    v_exp_f32 v39, v39
    v_mfma_f32_32x32x16_bf16 v[80:95], v[112:115], v[76:79], v[80:95]
    ds_read_b128 v[112:115], v2 offset:11264
    v_mfma_f32_16x16x32_bf16 v[200:203], v[184:187], v[232:235], 0
    v_mfma_f32_16x16x32_bf16 v[204:207], v[184:187], v[236:239], 0
    v_cvt_pk_bf16_f32 v64, v32, v33
    v_cvt_pk_bf16_f32 v65, v34, v35
    v_cvt_pk_bf16_f32 v66, v36, v37
    v_cvt_pk_bf16_f32 v67, v38, v39
    v_exp_f32 v40, v40
    v_exp_f32 v41, v41
    v_smfmac_f32_16x16x64_bf16 v[96:99], v[116:119], v[72:79], v120
    s_waitcnt lgkmcnt(1)
    v_exp_f32 v42, v42
    v_exp_f32 v43, v43
    v_exp_f32 v44, v44
    v_exp_f32 v45, v45
    v_mfma_f32_32x32x16_bf16 v[80:95], v[108:111], v[64:67], v[80:95]
    ds_read_b128 v[108:111], v2 offset:14336
    s_add_u32 m0, s98, 49152
    s_and_b32 s55, s0, 0x3ffff
    buffer_load_dwordx4 v2, s[84:87], s55 offen offset:0 sc1 lds
    v_exp_f32 v46, v46
    v_exp_f32 v47, v47
    s_setprio 2
    v_cvt_pk_bf16_f32 v68, v40, v41
    v_cvt_pk_bf16_f32 v69, v42, v43
    v_cvt_pk_bf16_f32 v70, v44, v45
    v_cvt_pk_bf16_f32 v71, v46, v47
    v_mfma_f32_32x32x16_bf16 v[32:47], v[100:103], v[8:11], v[16:31]
    ds_read_b128 v[100:103], v2 offset:20480
    v_exp_f32 v48, v48
    v_exp_f32 v49, v49
    v_exp_f32 v50, v50
    v_exp_f32 v51, v51
    v_mfma_f32_32x32x16_bf16 v[32:47], v[104:107], v[12:15], v[32:47]
    ds_read_b128 v[104:107], v2 offset:21504
    s_add_u32 m0, s98, 49152
    s_add_u32 s0, s55, 16384
    buffer_load_dwordx4 v2, s[84:87], s55 offen offset:1024 sc1 lds
    v_exp_f32 v52, v52
    v_exp_f32 v53, v53
    v_exp_f32 v54, v54
    v_exp_f32 v55, v55
    s_waitcnt lgkmcnt(3)
    v_mfma_f32_32x32x16_bf16 v[80:95], v[112:115], v[68:71], v[80:95]
    ds_read_b128 v[112:115], v2 offset:15360
    s_mov_b64 exec, 0xffff
    ds_write_b32 v180, v192 offset:0
    ds_write_b32 v180, v196 offset:512
    ds_write_b32 v180, v200 offset:1024
    ds_write_b32 v180, v204 offset:1536
    s_mov_b64 exec, -1
    v_cvt_pk_bf16_f32 v72, v48, v49
    v_cvt_pk_bf16_f32 v73, v50, v51
    v_cvt_pk_bf16_f32 v74, v52, v53
    v_cvt_pk_bf16_f32 v75, v54, v55
    v_exp_f32 v56, v56
    v_exp_f32 v57, v57
    v_smfmac_f32_16x16x64_bf16 v[96:99], v[116:119], v[64:71], v120
    s_waitcnt lgkmcnt(5)
    v_exp_f32 v58, v58
    v_exp_f32 v59, v59
    v_exp_f32 v60, v60
    v_exp_f32 v61, v61
    v_mfma_f32_32x32x16_bf16 v[80:95], v[108:111], v[72:75], v[80:95]
    ds_read_b128 v[108:111], v2 offset:18432
    v_mfma_f32_16x16x32_bf16 v[192:195], v[184:187], v[240:243], 0
    v_mfma_f32_16x16x32_bf16 v[196:199], v[184:187], v[244:247], 0
    v_exp_f32 v62, v62
    v_exp_f32 v63, v63
    s_setprio 1
    v_cvt_pk_bf16_f32 v76, v56, v57
    v_cvt_pk_bf16_f32 v77, v58, v59
    v_cvt_pk_bf16_f32 v78, v60, v61
    v_cvt_pk_bf16_f32 v79, v62, v63
    v_mfma_f32_32x32x16_bf16 v[48:63], v[100:103], v[8:11], v[16:31]
    ds_read_b128 v[100:103], v2 offset:24576
    v_exp_f32 v32, v32
    v_exp_f32 v33, v33
    v_exp_f32 v34, v34
    v_exp_f32 v35, v35
    v_mfma_f32_32x32x16_bf16 v[48:63], v[104:107], v[12:15], v[48:63]
    ds_read_b128 v[104:107], v2 offset:25600
    v_mfma_f32_16x16x32_bf16 v[200:203], v[184:187], v[248:251], 0
    v_mfma_f32_16x16x32_bf16 v[204:207], v[184:187], v[252:255], 0
    v_exp_f32 v36, v36
    v_exp_f32 v37, v37
    v_exp_f32 v38, v38
    v_exp_f32 v39, v39
    s_waitcnt lgkmcnt(7)
    v_mfma_f32_32x32x16_bf16 v[80:95], v[112:115], v[76:79], v[80:95]
    ds_read_b128 v[112:115], v2 offset:19456
    s_add_u32 m0, s98, 65536
    s_nop 0
    buffer_load_dwordx4 v121, s[56:59], s27 offen lds
    v_cvt_pk_bf16_f32 v64, v32, v33
    v_cvt_pk_bf16_f32 v65, v34, v35
    v_cvt_pk_bf16_f32 v66, v36, v37
    v_cvt_pk_bf16_f32 v67, v38, v39
    v_exp_f32 v40, v40
    v_exp_f32 v41, v41
    v_smfmac_f32_16x16x64_bf16 v[96:99], v[116:119], v[72:79], v120
    s_waitcnt lgkmcnt(1)
    v_exp_f32 v42, v42
    v_exp_f32 v43, v43
    v_exp_f32 v44, v44
    v_exp_f32 v45, v45
    v_mfma_f32_32x32x16_bf16 v[80:95], v[108:111], v[64:67], v[80:95]
    ds_read_b128 v[108:111], v2 offset:22528
    s_add_u32 m0, s98, 66560
    s_add_u32 s1, s27, 0x20000
    buffer_load_dwordx4 v125, s[56:59], s27 offen lds
    v_exp_f32 v46, v46
    v_exp_f32 v47, v47
    s_setprio 0
    v_cvt_pk_bf16_f32 v68, v40, v41
    v_cvt_pk_bf16_f32 v69, v42, v43
    v_cvt_pk_bf16_f32 v70, v44, v45
    v_cvt_pk_bf16_f32 v71, v46, v47
    v_mfma_f32_32x32x16_bf16 v[32:47], v[100:103], v[8:11], v[16:31]
    ds_read_b128 v[100:103], v2 offset:28672
    v_exp_f32 v48, v48
    v_exp_f32 v49, v49
    v_exp_f32 v50, v50
    v_exp_f32 v51, v51
    v_mfma_f32_32x32x16_bf16 v[32:47], v[104:107], v[12:15], v[32:47]
    ds_read_b128 v[104:107], v2 offset:29696
    s_mov_b64 exec, 0xffff
    ds_write_b32 v180, v192 offset:2048
    ds_write_b32 v180, v196 offset:2560
    ds_write_b32 v180, v200 offset:3072
    ds_write_b32 v180, v204 offset:3584
    s_mov_b64 exec, -1
    v_exp_f32 v52, v52
    v_exp_f32 v53, v53
    v_exp_f32 v54, v54
    v_exp_f32 v55, v55
    s_waitcnt lgkmcnt(7)
    v_mfma_f32_32x32x16_bf16 v[80:95], v[112:115], v[68:71], v[80:95]
    ds_read_b128 v[112:115], v2 offset:23552
    s_add_u32 m0, s98, 81920
    s_and_b32 s27, s1, 0x1fffff
    buffer_load_dwordx4 v121, s[56:59], s27 offen lds
    v_cvt_pk_bf16_f32 v72, v48, v49
    v_cvt_pk_bf16_f32 v73, v50, v51
    v_cvt_pk_bf16_f32 v74, v52, v53
    v_cvt_pk_bf16_f32 v75, v54, v55
    v_exp_f32 v56, v56
    v_exp_f32 v57, v57
    v_smfmac_f32_16x16x64_bf16 v[96:99], v[116:119], v[64:71], v120
    s_waitcnt lgkmcnt(5)
    v_exp_f32 v58, v58
    v_exp_f32 v59, v59
    v_exp_f32 v60, v60
    v_exp_f32 v61, v61
    v_mfma_f32_32x32x16_bf16 v[80:95], v[108:111], v[72:75], v[80:95]
    ds_read_b128 v[108:111], v2 offset:26624
    s_add_u32 m0, s98, 82944
    s_add_u32 s1, s27, 0x20000
    buffer_load_dwordx4 v125, s[56:59], s27 offen lds
    v_exp_f32 v62, v62
    v_exp_f32 v63, v63
    s_setprio 3
    v_cvt_pk_bf16_f32 v76, v56, v57
    v_cvt_pk_bf16_f32 v77, v58, v59
    v_cvt_pk_bf16_f32 v78, v60, v61
    v_cvt_pk_bf16_f32 v79, v62, v63
    v_mfma_f32_32x32x16_bf16 v[48:63], v[100:103], v[8:11], v[16:31]
    s_waitcnt lgkmcnt(2)
    s_waitcnt vmcnt(8)
    s_barrier
    ds_read_b128 v[100:103], v2 offset:32768
    v_exp_f32 v32, v32
    v_exp_f32 v33, v33
    v_exp_f32 v34, v34
    v_exp_f32 v35, v35
    v_mfma_f32_32x32x16_bf16 v[48:63], v[104:107], v[12:15], v[48:63]
    ds_read_b128 v[104:107], v2 offset:33792
    s_cmp_eq_u32 s60, 2
    s_cbranch_scc0 L_rx_106
    v_lshlrev_b32 v124, 5, v1
    v_add_u32 v124, 151552, v124
    ds_read_b128 v[192:195], v124 offset:0
    ds_read_b128 v[196:199], v124 offset:16
    ds_read_b128 v[200:203], v124 offset:2048
    ds_read_b128 v[204:207], v124 offset:2064
    s_waitcnt lgkmcnt(0)
    v_add_f32 v192, v192, v193
    v_add_f32 v200, v200, v201
    v_add_f32 v192, v192, v194
    v_add_f32 v200, v200, v202
    v_add_f32 v192, v192, v195
    v_add_f32 v200, v200, v203
    v_add_f32 v192, v192, v196
    v_add_f32 v200, v200, v204
    v_add_f32 v192, v192, v197
    v_add_f32 v200, v200, v205
    v_add_f32 v192, v192, v198
    v_add_f32 v200, v200, v206
    v_add_f32 v192, v192, v199
    v_add_f32 v200, v200, v207
    v_mov_b32 v193, 1
    v_mov_b32 v194, v200
    v_mov_b32 v195, 1
    buffer_store_dwordx4 v[192:195], v2, s[84:87], s25 offen sc1
L_rx_106:
    v_exp_f32 v36, v36
    v_exp_f32 v37, v37
    v_exp_f32 v38, v38
    v_exp_f32 v39, v39
    s_waitcnt lgkmcnt(3)
    v_mfma_f32_32x32x16_bf16 v[80:95], v[112:115], v[76:79], v[80:95]
    ds_read_b128 v[112:115], v2 offset:27648
    s_waitcnt vmcnt(11)
    s_cmp_eq_u32 s60, 2
    s_cbranch_scc1 L_we_108
    s_waitcnt vmcnt(10)
L_we_108:
    ds_read_b64_tr_b16 v[208:209], v177 offset:0
    ds_read_b64_tr_b16 v[210:211], v177 offset:256
    ds_read_b64_tr_b16 v[212:213], v177 offset:1024
    ds_read_b64_tr_b16 v[214:215], v177 offset:1280
    v_cvt_pk_bf16_f32 v64, v32, v33
    v_cvt_pk_bf16_f32 v65, v34, v35
    v_cvt_pk_bf16_f32 v66, v36, v37
    v_cvt_pk_bf16_f32 v67, v38, v39
    v_exp_f32 v40, v40
    v_exp_f32 v41, v41
    v_smfmac_f32_16x16x64_bf16 v[96:99], v[116:119], v[72:79], v120
    s_waitcnt lgkmcnt(5)
    v_exp_f32 v42, v42
    v_exp_f32 v43, v43
    v_exp_f32 v44, v44
    v_exp_f32 v45, v45
    v_mfma_f32_32x32x16_bf16 v[80:95], v[108:111], v[64:67], v[80:95]
    ds_read_b128 v[108:111], v2 offset:30720
    s_add_u32 m0, s98, 0
    s_and_b32 s55, s0, 0x3ffff
    buffer_load_dwordx4 v2, s[84:87], s55 offen offset:0 sc1 lds
    v_exp_f32 v46, v46
    v_exp_f32 v47, v47
    s_setprio 2
    v_cvt_pk_bf16_f32 v68, v40, v41
    v_cvt_pk_bf16_f32 v69, v42, v43
    v_cvt_pk_bf16_f32 v70, v44, v45
    v_cvt_pk_bf16_f32 v71, v46, v47
    v_mfma_f32_32x32x16_bf16 v[32:47], v[100:103], v[8:11], v[16:31]
    ds_read_b128 v[100:103], v2 offset:36864
    v_exp_f32 v48, v48
    v_exp_f32 v49, v49
    v_exp_f32 v50, v50
    v_exp_f32 v51, v51
    v_mfma_f32_32x32x16_bf16 v[32:47], v[104:107], v[12:15], v[32:47]
    ds_read_b128 v[104:107], v2 offset:37888
    s_add_u32 m0, s98, 0
    s_add_u32 s0, s55, 16384
    buffer_load_dwordx4 v2, s[84:87], s55 offen offset:1024 sc1 lds
    v_exp_f32 v52, v52
    v_exp_f32 v53, v53
    v_exp_f32 v54, v54
    v_exp_f32 v55, v55
    s_waitcnt lgkmcnt(7)
    v_mfma_f32_32x32x16_bf16 v[80:95], v[112:115], v[68:71], v[80:95]
    ds_read_b128 v[112:115], v2 offset:31744
    s_waitcnt lgkmcnt(4)
    v_cvt_pk_bf16_f32 v72, v48, v49
    v_cvt_pk_bf16_f32 v73, v50, v51
    v_cvt_pk_bf16_f32 v74, v52, v53
    v_cvt_pk_bf16_f32 v75, v54, v55
    v_exp_f32 v56, v56
    v_exp_f32 v57, v57
    v_smfmac_f32_16x16x64_bf16 v[96:99], v[116:119], v[64:71], v120
    s_waitcnt lgkmcnt(1)
    v_exp_f32 v58, v58
    v_exp_f32 v59, v59
    v_exp_f32 v60, v60
    v_exp_f32 v61, v61
    v_mfma_f32_32x32x16_bf16 v[80:95], v[108:111], v[72:75], v[80:95]
    ds_read_b128 v[108:111], v2 offset:34816
    s_add_u32 m0, s98, 131072
    s_add_u32 s10, s93, 65536
    buffer_load_dwordx4 v127, s[72:75], s10 offen lds
    v_exp_f32 v62, v62
    v_exp_f32 v63, v63
    s_setprio 1
    v_cvt_pk_bf16_f32 v76, v56, v57
    v_cvt_pk_bf16_f32 v77, v58, v59
    v_cvt_pk_bf16_f32 v78, v60, v61
    v_cvt_pk_bf16_f32 v79, v62, v63
    v_mfma_f32_32x32x16_bf16 v[48:63], v[100:103], v[8:11], v[16:31]
    ds_read_b128 v[100:103], v2 offset:40960
    v_exp_f32 v32, v32
    v_exp_f32 v33, v33
    v_exp_f32 v34, v34
    v_exp_f32 v35, v35
    v_mfma_f32_32x32x16_bf16 v[48:63], v[104:107], v[12:15], v[48:63]
    ds_read_b128 v[104:107], v2 offset:41984
    s_add_u32 m0, s98, 132096
    s_add_u32 s10, s93, 98304
    buffer_load_dwordx4 v127, s[72:75], s10 offen lds
    v_exp_f32 v36, v36
    v_exp_f32 v37, v37
    v_exp_f32 v38, v38
    v_exp_f32 v39, v39
    s_waitcnt lgkmcnt(3)
    v_mfma_f32_32x32x16_bf16 v[80:95], v[112:115], v[76:79], v[80:95]
    ds_read_b128 v[112:115], v2 offset:35840
    s_add_u32 m0, s98, 98304
    s_and_b32 s27, s1, 0x1fffff
    buffer_load_dwordx4 v121, s[56:59], s27 offen lds
    v_cvt_pk_bf16_f32 v64, v32, v33
    v_cvt_pk_bf16_f32 v65, v34, v35
    v_cvt_pk_bf16_f32 v66, v36, v37
    v_cvt_pk_bf16_f32 v67, v38, v39
    v_exp_f32 v40, v40
    v_exp_f32 v41, v41
    v_smfmac_f32_16x16x64_bf16 v[96:99], v[116:119], v[72:79], v120
    s_waitcnt lgkmcnt(1)
    v_exp_f32 v42, v42
    v_exp_f32 v43, v43
    v_exp_f32 v44, v44
    v_exp_f32 v45, v45
    v_mfma_f32_32x32x16_bf16 v[80:95], v[108:111], v[64:67], v[80:95]
    ds_read_b128 v[108:111], v2 offset:38912
    s_add_u32 m0, s98, 99328
    s_add_u32 s1, s27, 0x20000
    buffer_load_dwordx4 v125, s[56:59], s27 offen lds
    v_exp_f32 v46, v46
    v_exp_f32 v47, v47
    s_setprio 0
    v_cvt_pk_bf16_f32 v68, v40, v41
    v_cvt_pk_bf16_f32 v69, v42, v43
    v_cvt_pk_bf16_f32 v70, v44, v45
    v_cvt_pk_bf16_f32 v71, v46, v47
    v_mfma_f32_32x32x16_bf16 v[32:47], v[100:103], v[8:11], v[16:31]
    ds_read_b128 v[100:103], v2 offset:45056
    v_exp_f32 v48, v48
    v_exp_f32 v49, v49
    v_exp_f32 v50, v50
    v_exp_f32 v51, v51
    v_mfma_f32_32x32x16_bf16 v[32:47], v[104:107], v[12:15], v[32:47]
    ds_read_b128 v[104:107], v2 offset:46080
    s_add_u32 m0, s98, 114688
    s_and_b32 s27, s1, 0x1fffff
    buffer_load_dwordx4 v121, s[56:59], s27 offen lds
    v_exp_f32 v52, v52
    v_exp_f32 v53, v53
    v_exp_f32 v54, v54
    v_exp_f32 v55, v55
    s_waitcnt lgkmcnt(3)
    v_mfma_f32_32x32x16_bf16 v[80:95], v[112:115], v[68:71], v[80:95]
    ds_read_b128 v[112:115], v2 offset:39936
    s_add_u32 m0, s98, 115712
    s_add_u32 s1, s27, 0x20000
    buffer_load_dwordx4 v125, s[56:59], s27 offen lds
    v_cvt_pk_bf16_f32 v72, v48, v49
    v_cvt_pk_bf16_f32 v73, v50, v51
    v_cvt_pk_bf16_f32 v74, v52, v53
    v_cvt_pk_bf16_f32 v75, v54, v55
    v_exp_f32 v56, v56
    v_exp_f32 v57, v57
    v_smfmac_f32_16x16x64_bf16 v[96:99], v[116:119], v[64:71], v120
    s_waitcnt lgkmcnt(1)
    v_exp_f32 v58, v58
    v_exp_f32 v59, v59
    v_exp_f32 v60, v60
    v_exp_f32 v61, v61
    v_mfma_f32_32x32x16_bf16 v[80:95], v[108:111], v[72:75], v[80:95]
    ds_read_b128 v[108:111], v2 offset:43008
    v_exp_f32 v62, v62
    v_exp_f32 v63, v63
    s_setprio 3
    v_cvt_pk_bf16_f32 v76, v56, v57
    v_cvt_pk_bf16_f32 v77, v58, v59
    v_cvt_pk_bf16_f32 v78, v60, v61
    v_cvt_pk_bf16_f32 v79, v62, v63
    v_mfma_f32_32x32x16_bf16 v[48:63], v[100:103], v[8:11], v[16:31]
    s_waitcnt vmcnt(9)
    s_cmp_eq_u32 s60, 2
    s_cbranch_scc1 L_we_109
    s_waitcnt vmcnt(8)
L_we_109:
    s_barrier
    ds_read_b128 v[100:103], v2 offset:49152
    v_exp_f32 v32, v32
    v_exp_f32 v33, v33
    v_exp_f32 v34, v34
    v_exp_f32 v35, v35
    v_mfma_f32_32x32x16_bf16 v[48:63], v[104:107], v[12:15], v[48:63]
    ds_read_b128 v[104:107], v2 offset:50176
    ds_read_b64_tr_b16 v[128:129], v5 offset:0
    ds_read_b64_tr_b16 v[130:131], v5 offset:1024
    ds_read_b64_tr_b16 v[132:133], v5 offset:8192
    ds_read_b64_tr_b16 v[134:135], v5 offset:9216
    v_exp_f32 v36, v36
    v_exp_f32 v37, v37
    v_exp_f32 v38, v38
    v_exp_f32 v39, v39
    s_waitcnt lgkmcnt(7)
    v_mfma_f32_32x32x16_bf16 v[80:95], v[112:115], v[76:79], v[80:95]
    ds_read_b128 v[112:115], v2 offset:44032
    ds_read_b64_tr_b16 v[136:137], v5 offset:16384
    ds_read_b64_tr_b16 v[138:139], v5 offset:17408
    ds_read_b64_tr_b16 v[140:141], v5 offset:24576
    ds_read_b64_tr_b16 v[142:143], v5 offset:25600
    v_cvt_pk_bf16_f32 v64, v32, v33
    v_cvt_pk_bf16_f32 v65, v34, v35
    v_cvt_pk_bf16_f32 v66, v36, v37
    v_cvt_pk_bf16_f32 v67, v38, v39
    v_exp_f32 v40, v40
    v_exp_f32 v41, v41
    v_smfmac_f32_16x16x64_bf16 v[96:99], v[116:119], v[72:79], v120
    s_waitcnt lgkmcnt(9)
    v_exp_f32 v42, v42
    v_exp_f32 v43, v43
    v_exp_f32 v44, v44
    v_exp_f32 v45, v45
    v_mfma_f32_32x32x16_bf16 v[80:95], v[108:111], v[64:67], v[80:95]
    ds_read_b128 v[108:111], v2 offset:47104
    s_add_u32 m0, s98, 16384
    s_and_b32 s55, s0, 0x3ffff
    buffer_load_dwordx4 v2, s[84:87], s55 offen offset:0 sc1 lds
    v_exp_f32 v46, v46
    v_exp_f32 v47, v47
    s_setprio 2
    v_cvt_pk_bf16_f32 v68, v40, v41
    v_cvt_pk_bf16_f32 v69, v42, v43
    v_cvt_pk_bf16_f32 v70, v44, v45
    v_cvt_pk_bf16_f32 v71, v46, v47
    v_mfma_f32_32x32x16_bf16 v[32:47], v[100:103], v[8:11], v[16:31]
    ds_read_b128 v[100:103], v2 offset:53248
    v_exp_f32 v48, v48
    v_exp_f32 v49, v49
    v_exp_f32 v50, v50
    v_exp_f32 v51, v51
    v_mfma_f32_32x32x16_bf16 v[32:47], v[104:107], v[12:15], v[32:47]
    ds_read_b128 v[104:107], v2 offset:54272
    s_add_u32 m0, s98, 16384
    s_add_u32 s0, s55, 16384
    buffer_load_dwordx4 v2, s[84:87], s55 offen offset:1024 sc1 lds
    v_exp_f32 v52, v52
    v_exp_f32 v53, v53
    v_exp_f32 v54, v54
    v_exp_f32 v55, v55
    s_waitcnt lgkmcnt(7)
    v_mfma_f32_32x32x16_bf16 v[80:95], v[112:115], v[68:71], v[80:95]
    ds_read_b128 v[112:115], v2 offset:48128
    s_waitcnt vmcnt(17)
    s_cmp_eq_u32 s60, 2
    s_cbranch_scc1 L_we_110
    s_waitcnt vmcnt(16)
L_we_110:
    s_lshl_b32 s10, s4, 8
    s_add_u32 s10, s10, 1572864
    s_lshl_b32 s11, s5, 5
    s_lshl_b32 s12, s3, 2
    s_add_u32 s11, s11, s12
    v_mov_b32 v123, 1
    v_mov_b32 v124, s11
    s_mov_b64 exec, 1
    buffer_store_dword v123, v124, s[84:87], s10 offen sc1
    s_mov_b64 exec, -1
    v_cvt_pk_bf16_f32 v72, v48, v49
    v_cvt_pk_bf16_f32 v73, v50, v51
    v_cvt_pk_bf16_f32 v74, v52, v53
    v_cvt_pk_bf16_f32 v75, v54, v55
    v_exp_f32 v56, v56
    v_exp_f32 v57, v57
    v_smfmac_f32_16x16x64_bf16 v[96:99], v[116:119], v[64:71], v120
    s_waitcnt lgkmcnt(1)
    v_exp_f32 v58, v58
    v_exp_f32 v59, v59
    v_exp_f32 v60, v60
    v_exp_f32 v61, v61
    v_mfma_f32_32x32x16_bf16 v[80:95], v[108:111], v[72:75], v[80:95]
    ds_read_b128 v[108:111], v2 offset:51200
    v_exp_f32 v62, v62
    v_exp_f32 v63, v63
    s_setprio 1
    v_cvt_pk_bf16_f32 v76, v56, v57
    v_cvt_pk_bf16_f32 v77, v58, v59
    v_cvt_pk_bf16_f32 v78, v60, v61
    v_cvt_pk_bf16_f32 v79, v62, v63
    v_mfma_f32_32x32x16_bf16 v[48:63], v[100:103], v[8:11], v[16:31]
    ds_read_b128 v[100:103], v2 offset:57344
    v_exp_f32 v32, v32
    v_exp_f32 v33, v33
    v_exp_f32 v34, v34
    v_exp_f32 v35, v35
    v_mfma_f32_32x32x16_bf16 v[48:63], v[104:107], v[12:15], v[48:63]
    ds_read_b128 v[104:107], v2 offset:58368
    buffer_load_dwordx4 v[224:227], v2, s[84:87], s24 offen offset:0 sc1
    v_exp_f32 v36, v36
    v_exp_f32 v37, v37
    v_exp_f32 v38, v38
    v_exp_f32 v39, v39
    s_waitcnt lgkmcnt(3)
    v_mfma_f32_32x32x16_bf16 v[80:95], v[112:115], v[76:79], v[80:95]
    ds_read_b128 v[112:115], v2 offset:52224
    buffer_load_dwordx4 v[228:231], v2, s[84:87], s24 offen offset:1024 sc1
    v_cvt_pk_bf16_f32 v64, v32, v33
    v_cvt_pk_bf16_f32 v65, v34, v35
    v_cvt_pk_bf16_f32 v66, v36, v37
    v_cvt_pk_bf16_f32 v67, v38, v39
    v_exp_f32 v40, v40
    v_exp_f32 v41, v41
    v_smfmac_f32_16x16x64_bf16 v[96:99], v[116:119], v[72:79], v120
    s_waitcnt lgkmcnt(1)
    v_exp_f32 v42, v42
    v_exp_f32 v43, v43
    v_exp_f32 v44, v44
    v_exp_f32 v45, v45
    v_mfma_f32_32x32x16_bf16 v[80:95], v[108:111], v[64:67], v[80:95]
    ds_read_b128 v[108:111], v2 offset:55296
    buffer_load_dwordx4 v[232:235], v2, s[84:87], s24 offen offset:2048 sc1
    v_exp_f32 v46, v46
    v_exp_f32 v47, v47
    s_setprio 0
    v_cvt_pk_bf16_f32 v68, v40, v41
    v_cvt_pk_bf16_f32 v69, v42, v43
    v_cvt_pk_bf16_f32 v70, v44, v45
    v_cvt_pk_bf16_f32 v71, v46, v47
    v_mfma_f32_32x32x16_bf16 v[32:47], v[100:103], v[8:11], v[16:31]
    ds_read_b128 v[100:103], v2 offset:61440
    v_exp_f32 v48, v48
    v_exp_f32 v49, v49
    v_exp_f32 v50, v50
    v_exp_f32 v51, v51
    v_mfma_f32_32x32x16_bf16 v[32:47], v[104:107], v[12:15], v[32:47]
    ds_read_b128 v[104:107], v2 offset:62464
    buffer_load_dwordx4 v[236:239], v2, s[84:87], s24 offen offset:3072 sc1
    v_exp_f32 v52, v52
    v_exp_f32 v53, v53
    v_exp_f32 v54, v54
    v_exp_f32 v55, v55
    s_waitcnt lgkmcnt(3)
    v_mfma_f32_32x32x16_bf16 v[80:95], v[112:115], v[68:71], v[80:95]
    ds_read_b128 v[112:115], v2 offset:56320
    v_cvt_pk_bf16_f32 v72, v48, v49
    v_cvt_pk_bf16_f32 v73, v50, v51
    v_cvt_pk_bf16_f32 v74, v52, v53
    v_cvt_pk_bf16_f32 v75, v54, v55
    v_exp_f32 v56, v56
    v_exp_f32 v57, v57
    v_smfmac_f32_16x16x64_bf16 v[96:99], v[116:119], v[64:71], v120
    s_waitcnt lgkmcnt(1)
    v_exp_f32 v58, v58
    v_exp_f32 v59, v59
    v_exp_f32 v60, v60
    v_exp_f32 v61, v61
    v_mfma_f32_32x32x16_bf16 v[80:95], v[108:111], v[72:75], v[80:95]
    ds_read_b128 v[108:111], v2 offset:59392
    v_exp_f32 v62, v62
    v_exp_f32 v63, v63
    s_setprio 3
    v_cvt_pk_bf16_f32 v76, v56, v57
    v_cvt_pk_bf16_f32 v77, v58, v59
    v_cvt_pk_bf16_f32 v78, v60, v61
    v_cvt_pk_bf16_f32 v79, v62, v63
    v_mfma_f32_32x32x16_bf16 v[48:63], v[100:103], v[8:11], v[16:31]
    s_waitcnt vmcnt(7)
    s_barrier
    ds_read_b128 v[100:103], v2 offset:0
    v_exp_f32 v32, v32
    v_exp_f32 v33, v33
    v_exp_f32 v34, v34
    v_exp_f32 v35, v35
    v_mfma_f32_32x32x16_bf16 v[48:63], v[104:107], v[12:15], v[48:63]
    ds_read_b128 v[104:107], v2 offset:1024
    ds_read_b64_tr_b16 v[144:145], v5 offset:32768
    ds_read_b64_tr_b16 v[146:147], v5 offset:33792
    ds_read_b64_tr_b16 v[148:149], v5 offset:40960
    ds_read_b64_tr_b16 v[150:151], v5 offset:41984
    v_exp_f32 v36, v36
    v_exp_f32 v37, v37
    v_exp_f32 v38, v38
    v_exp_f32 v39, v39
    s_waitcnt lgkmcnt(7)
    v_mfma_f32_32x32x16_bf16 v[80:95], v[112:115], v[76:79], v[80:95]
    ds_read_b128 v[112:115], v2 offset:60416
    ds_read_b64_tr_b16 v[152:153], v5 offset:49152
    ds_read_b64_tr_b16 v[154:155], v5 offset:50176
    ds_read_b64_tr_b16 v[156:157], v5 offset:57344
    ds_read_b64_tr_b16 v[158:159], v5 offset:58368
    v_cvt_pk_bf16_f32 v64, v32, v33
    v_cvt_pk_bf16_f32 v65, v34, v35
    v_cvt_pk_bf16_f32 v66, v36, v37
    v_cvt_pk_bf16_f32 v67, v38, v39
    v_exp_f32 v40, v40
    v_exp_f32 v41, v41
    v_smfmac_f32_16x16x64_bf16 v[96:99], v[116:119], v[72:79], v120
    s_waitcnt lgkmcnt(9)
    v_exp_f32 v42, v42
    v_exp_f32 v43, v43
    v_exp_f32 v44, v44
    v_exp_f32 v45, v45
    v_mfma_f32_32x32x16_bf16 v[80:95], v[108:111], v[64:67], v[80:95]
    ds_read_b128 v[108:111], v2 offset:63488
    s_add_u32 m0, s98, 65536
    s_and_b32 s27, s1, 0x1fffff
    buffer_load_dwordx4 v121, s[56:59], s27 offen lds
    v_exp_f32 v46, v46
    v_exp_f32 v47, v47
    s_setprio 2
    v_cvt_pk_bf16_f32 v68, v40, v41
    v_cvt_pk_bf16_f32 v69, v42, v43
    v_cvt_pk_bf16_f32 v70, v44, v45
    v_cvt_pk_bf16_f32 v71, v46, v47
    v_mfma_f32_32x32x16_bf16 v[32:47], v[100:103], v[8:11], v[16:31]
    ds_read_b128 v[100:103], v2 offset:4096
    v_exp_f32 v48, v48
    v_exp_f32 v49, v49
    v_exp_f32 v50, v50
    v_exp_f32 v51, v51
    v_mfma_f32_32x32x16_bf16 v[32:47], v[104:107], v[12:15], v[32:47]
    ds_read_b128 v[104:107], v2 offset:5120
    s_add_u32 m0, s98, 66560
    s_add_u32 s1, s27, 0x20000
    buffer_load_dwordx4 v125, s[56:59], s27 offen lds
    v_exp_f32 v52, v52
    v_exp_f32 v53, v53
    v_exp_f32 v54, v54
    v_exp_f32 v55, v55
    s_waitcnt lgkmcnt(7)
    v_mfma_f32_32x32x16_bf16 v[80:95], v[112:115], v[68:71], v[80:95]
    ds_read_b128 v[112:115], v2 offset:64512
    s_add_u32 m0, s98, 81920
    s_and_b32 s27, s1, 0x1fffff
    buffer_load_dwordx4 v121, s[56:59], s27 offen lds
    v_cvt_pk_bf16_f32 v72, v48, v49
    v_cvt_pk_bf16_f32 v73, v50, v51
    v_cvt_pk_bf16_f32 v74, v52, v53
    v_cvt_pk_bf16_f32 v75, v54, v55
    v_exp_f32 v56, v56
    v_exp_f32 v57, v57
    v_smfmac_f32_16x16x64_bf16 v[96:99], v[116:119], v[64:71], v120
    s_waitcnt lgkmcnt(1)
    v_exp_f32 v58, v58
    v_exp_f32 v59, v59
    v_exp_f32 v60, v60
    v_exp_f32 v61, v61
    v_mfma_f32_32x32x16_bf16 v[80:95], v[108:111], v[72:75], v[80:95]
    ds_read_b128 v[108:111], v2 offset:2048
    s_add_u32 m0, s98, 82944
    s_add_u32 s1, s27, 0x20000
    buffer_load_dwordx4 v125, s[56:59], s27 offen lds
    v_exp_f32 v62, v62
    v_exp_f32 v63, v63
    s_setprio 1
    v_cvt_pk_bf16_f32 v76, v56, v57
    v_cvt_pk_bf16_f32 v77, v58, v59
    v_cvt_pk_bf16_f32 v78, v60, v61
    v_cvt_pk_bf16_f32 v79, v62, v63
    v_mfma_f32_32x32x16_bf16 v[48:63], v[100:103], v[8:11], v[16:31]
    ds_read_b128 v[100:103], v2 offset:8192
    v_exp_f32 v32, v32
    v_exp_f32 v33, v33
    v_exp_f32 v34, v34
    v_exp_f32 v35, v35
    v_mfma_f32_32x32x16_bf16 v[48:63], v[104:107], v[12:15], v[48:63]
    ds_read_b128 v[104:107], v2 offset:9216
    s_add_u32 m0, s98, 32768
    s_and_b32 s55, s0, 0x3ffff
    buffer_load_dwordx4 v2, s[84:87], s55 offen offset:0 sc1 lds
    v_exp_f32 v36, v36
    v_exp_f32 v37, v37
    v_exp_f32 v38, v38
    v_exp_f32 v39, v39
    s_waitcnt lgkmcnt(3)
    v_mfma_f32_32x32x16_bf16 v[80:95], v[112:115], v[76:79], v[80:95]
    ds_read_b128 v[112:115], v2 offset:3072
    s_add_u32 m0, s98, 32768
    s_add_u32 s0, s55, 16384
    buffer_load_dwordx4 v2, s[84:87], s55 offen offset:1024 sc1 lds
    v_cvt_pk_bf16_f32 v64, v32, v33
    v_cvt_pk_bf16_f32 v65, v34, v35
    v_cvt_pk_bf16_f32 v66, v36, v37
    v_cvt_pk_bf16_f32 v67, v38, v39
    v_exp_f32 v40, v40
    v_exp_f32 v41, v41
    v_smfmac_f32_16x16x64_bf16 v[96:99], v[116:119], v[72:79], v120
    s_waitcnt lgkmcnt(1)
    v_exp_f32 v42, v42
    v_exp_f32 v43, v43
    v_exp_f32 v44, v44
    v_exp_f32 v45, v45
    v_mfma_f32_32x32x16_bf16 v[80:95], v[108:111], v[64:67], v[80:95]
    ds_read_b128 v[108:111], v2 offset:6144
    s_waitcnt vmcnt(17)
    ds_read_b64_tr_b16 v[216:217], v177 offset:0
    ds_read_b64_tr_b16 v[218:219], v177 offset:256
    ds_read_b64_tr_b16 v[220:221], v177 offset:1024
    ds_read_b64_tr_b16 v[222:223], v177 offset:1280
    v_exp_f32 v46, v46
    v_exp_f32 v47, v47
    s_setprio 0
    v_cvt_pk_bf16_f32 v68, v40, v41
    v_cvt_pk_bf16_f32 v69, v42, v43
    v_cvt_pk_bf16_f32 v70, v44, v45
    v_cvt_pk_bf16_f32 v71, v46, v47
    v_mfma_f32_32x32x16_bf16 v[32:47], v[100:103], v[8:11], v[16:31]
    ds_read_b128 v[100:103], v2 offset:12288
    v_exp_f32 v48, v48
    v_exp_f32 v49, v49
    v_exp_f32 v50, v50
    v_exp_f32 v51, v51
    v_mfma_f32_32x32x16_bf16 v[32:47], v[104:107], v[12:15], v[32:47]
    ds_read_b128 v[104:107], v2 offset:13312
    s_waitcnt vmcnt(6)
    v_and_b32 v123, v225, v227
    v_and_b32 v124, v229, v231
    v_and_b32 v123, v123, v124
    v_and_b32 v124, v233, v235
    v_and_b32 v123, v123, v124
    v_and_b32 v124, v237, v239
    v_and_b32 v123, v123, v124
    v_cmp_ne_u32 vcc, 1, v123
    s_nop 0
    s_cbranch_vccnz L_rare_114
L_ret_116:
    v_add_f32 v224, v224, v228
    v_add_f32 v232, v232, v236
    v_add_f32 v224, v224, v232
    v_add_f32 v226, v226, v230
    v_add_f32 v234, v234, v238
    v_add_f32 v226, v226, v234
    v_cvt_pk_bf16_f32 v225, v224, v226
    v_lshlrev_b32 v224, 16, v225
    v_and_b32 v226, 0xffff0000, v225
    v_mul_f32 v225, 0xbfb8aa3b, v224
    v_exp_f32 v225, v225
    v_exp_f32 v52, v52
    v_exp_f32 v53, v53
    v_exp_f32 v54, v54
    v_exp_f32 v55, v55
    s_waitcnt lgkmcnt(7)
    v_mfma_f32_32x32x16_bf16 v[80:95], v[112:115], v[68:71], v[80:95]
    ds_read_b128 v[112:115], v2 offset:7168
    v_add_f32 v225, 1.0, v225
    v_rcp_f32 v225, v225
    s_nop 0
    v_mul_f32 v225, v225, v224
    v_cvt_pk_bf16_f32 v225, v225, v225
    v_and_b32 v225, 0xffff0000, v225
    v_mul_f32 v225, v225, v226
    v_cvt_pk_bf16_f32 v227, v225, v225
    ds_write_b16 v183, v227
    ds_read_b128 v[192:195], v178 offset:0
    ds_read_b128 v[196:199], v178 offset:32
    ds_read_b128 v[200:203], v178 offset:64
    ds_read_b128 v[204:207], v178 offset:96
    v_cvt_pk_bf16_f32 v72, v48, v49
    v_cvt_pk_bf16_f32 v73, v50, v51
    v_cvt_pk_bf16_f32 v74, v52, v53
    v_cvt_pk_bf16_f32 v75, v54, v55
    v_exp_f32 v56, v56
    v_exp_f32 v57, v57
    v_smfmac_f32_16x16x64_bf16 v[96:99], v[116:119], v[64:71], v120
    s_waitcnt lgkmcnt(6)
    v_exp_f32 v58, v58
    v_exp_f32 v59, v59
    v_exp_f32 v60, v60
    v_exp_f32 v61, v61
    v_mfma_f32_32x32x16_bf16 v[80:95], v[108:111], v[72:75], v[80:95]
    ds_read_b128 v[108:111], v2 offset:10240
    v_exp_f32 v62, v62
    v_exp_f32 v63, v63
    s_setprio 3
    v_cvt_pk_bf16_f32 v76, v56, v57
    v_cvt_pk_bf16_f32 v77, v58, v59
    v_cvt_pk_bf16_f32 v78, v60, v61
    v_cvt_pk_bf16_f32 v79, v62, v63
    v_mfma_f32_32x32x16_bf16 v[48:63], v[100:103], v[8:11], v[16:31]
    s_waitcnt vmcnt(11)
    s_barrier
    ds_read_b128 v[100:103], v2 offset:16384
    v_exp_f32 v32, v32
    v_exp_f32 v33, v33
    v_exp_f32 v34, v34
    v_exp_f32 v35, v35
    v_mfma_f32_32x32x16_bf16 v[48:63], v[104:107], v[12:15], v[48:63]
    ds_read_b128 v[104:107], v2 offset:17408
    s_waitcnt lgkmcnt(3)
    v_mfma_f32_16x16x32_bf16 v[184:187], v[192:195], v[208:211], 0
    v_mfma_f32_16x16x32_bf16 v[184:187], v[196:199], v[212:215], v[184:187]
    v_exp_f32 v36, v36
    v_exp_f32 v37, v37
    v_exp_f32 v38, v38
    v_exp_f32 v39, v39
    v_mfma_f32_32x32x16_bf16 v[80:95], v[112:115], v[76:79], v[80:95]
    ds_read_b128 v[112:115], v2 offset:11264
    v_mfma_f32_16x16x32_bf16 v[184:187], v[200:203], v[216:219], v[184:187]
    v_mfma_f32_16x16x32_bf16 v[184:187], v[204:207], v[220:223], v[184:187]
    v_cvt_pk_bf16_f32 v64, v32, v33
    v_cvt_pk_bf16_f32 v65, v34, v35
    v_cvt_pk_bf16_f32 v66, v36, v37
    v_cvt_pk_bf16_f32 v67, v38, v39
    v_exp_f32 v40, v40
    v_exp_f32 v41, v41
    v_smfmac_f32_16x16x64_bf16 v[96:99], v[116:119], v[72:79], v120
    s_waitcnt lgkmcnt(1)
    v_exp_f32 v42, v42
    v_exp_f32 v43, v43
    v_exp_f32 v44, v44
    v_exp_f32 v45, v45
    v_mfma_f32_32x32x16_bf16 v[80:95], v[108:111], v[64:67], v[80:95]
    ds_read_b128 v[108:111], v2 offset:14336
    s_add_u32 m0, s98, 98304
    s_and_b32 s27, s1, 0x1fffff
    buffer_load_dwordx4 v121, s[56:59], s27 offen lds
    v_exp_f32 v46, v46
    v_exp_f32 v47, v47
    s_setprio 2
    v_cvt_pk_bf16_f32 v68, v40, v41
    v_cvt_pk_bf16_f32 v69, v42, v43
    v_cvt_pk_bf16_f32 v70, v44, v45
    v_cvt_pk_bf16_f32 v71, v46, v47
    v_mfma_f32_32x32x16_bf16 v[32:47], v[100:103], v[8:11], v[16:31]
    ds_read_b128 v[100:103], v2 offset:20480
    v_exp_f32 v48, v48
    v_exp_f32 v49, v49
    v_exp_f32 v50, v50
    v_exp_f32 v51, v51
    v_mfma_f32_32x32x16_bf16 v[32:47], v[104:107], v[12:15], v[32:47]
    ds_read_b128 v[104:107], v2 offset:21504
    s_add_u32 m0, s98, 99328
    s_add_u32 s1, s27, 0x20000
    buffer_load_dwordx4 v125, s[56:59], s27 offen lds
    v_exp_f32 v52, v52
    v_exp_f32 v53, v53
    v_exp_f32 v54, v54
    v_exp_f32 v55, v55
    s_waitcnt lgkmcnt(3)
    v_mfma_f32_32x32x16_bf16 v[80:95], v[112:115], v[68:71], v[80:95]
    ds_read_b128 v[112:115], v2 offset:15360
    s_lshl_b32 s10, s3, 2
    s_add_u32 s10, s10, 156672
    v_lshl_add_u32 v123, v1, 5, s10
    s_mov_b32 exec_hi, 0
    ds_write_b32 v123, v184
    s_mov_b32 exec_hi, -1
    v_cvt_pk_bf16_f32 v72, v48, v49
    v_cvt_pk_bf16_f32 v73, v50, v51
    v_cvt_pk_bf16_f32 v74, v52, v53
    v_cvt_pk_bf16_f32 v75, v54, v55
    v_exp_f32 v56, v56
    v_exp_f32 v57, v57
    v_smfmac_f32_16x16x64_bf16 v[96:99], v[116:119], v[64:71], v120
    s_waitcnt lgkmcnt(2)
    v_exp_f32 v58, v58
    v_exp_f32 v59, v59
    v_exp_f32 v60, v60
    v_exp_f32 v61, v61
    v_mfma_f32_32x32x16_bf16 v[80:95], v[108:111], v[72:75], v[80:95]
    ds_read_b128 v[108:111], v2 offset:18432
    s_add_u32 m0, s98, 114688
    s_and_b32 s27, s1, 0x1fffff
    buffer_load_dwordx4 v121, s[56:59], s27 offen lds
    v_exp_f32 v62, v62
    v_exp_f32 v63, v63
    s_setprio 1
    v_cvt_pk_bf16_f32 v76, v56, v57
    v_cvt_pk_bf16_f32 v77, v58, v59
    v_cvt_pk_bf16_f32 v78, v60, v61
    v_cvt_pk_bf16_f32 v79, v62, v63
    v_mfma_f32_32x32x16_bf16 v[48:63], v[100:103], v[8:11], v[16:31]
    ds_read_b128 v[100:103], v2 offset:24576
    v_exp_f32 v32, v32
    v_exp_f32 v33, v33
    v_exp_f32 v34, v34
    v_exp_f32 v35, v35
    v_mfma_f32_32x32x16_bf16 v[48:63], v[104:107], v[12:15], v[48:63]
    ds_read_b128 v[104:107], v2 offset:25600
    s_add_u32 m0, s98, 115712
    s_add_u32 s1, s27, 0x20000
    buffer_load_dwordx4 v125, s[56:59], s27 offen lds
    v_exp_f32 v36, v36
    v_exp_f32 v37, v37
    v_exp_f32 v38, v38
    v_exp_f32 v39, v39
    s_waitcnt lgkmcnt(4)
    v_mfma_f32_32x32x16_bf16 v[80:95], v[112:115], v[76:79], v[80:95]
    ds_read_b128 v[112:115], v2 offset:19456
    s_add_u32 m0, s98, 49152
    s_and_b32 s55, s0, 0x3ffff
    buffer_load_dwordx4 v2, s[84:87], s55 offen offset:0 sc1 lds
    v_cvt_pk_bf16_f32 v64, v32, v33
    v_cvt_pk_bf16_f32 v65, v34, v35
    v_cvt_pk_bf16_f32 v66, v36, v37
    v_cvt_pk_bf16_f32 v67, v38, v39
    v_exp_f32 v40, v40
    v_exp_f32 v41, v41
    v_smfmac_f32_16x16x64_bf16 v[96:99], v[116:119], v[72:79], v120
    s_waitcnt lgkmcnt(1)
    v_exp_f32 v42, v42
    v_exp_f32 v43, v43
    v_exp_f32 v44, v44
    v_exp_f32 v45, v45
    v_mfma_f32_32x32x16_bf16 v[80:95], v[108:111], v[64:67], v[80:95]
    ds_read_b128 v[108:111], v2 offset:22528
    s_add_u32 m0, s98, 49152
    s_add_u32 s0, s55, 16384
    buffer_load_dwordx4 v2, s[84:87], s55 offen offset:1024 sc1 lds
    v_exp_f32 v46, v46
    v_exp_f32 v47, v47
    s_setprio 0
    v_cvt_pk_bf16_f32 v68, v40, v41
    v_cvt_pk_bf16_f32 v69, v42, v43
    v_cvt_pk_bf16_f32 v70, v44, v45
    v_cvt_pk_bf16_f32 v71, v46, v47
    v_mfma_f32_32x32x16_bf16 v[32:47], v[100:103], v[8:11], v[16:31]
    ds_read_b128 v[100:103], v2 offset:28672
    v_exp_f32 v48, v48
    v_exp_f32 v49, v49
    v_exp_f32 v50, v50
    v_exp_f32 v51, v51
    v_mfma_f32_32x32x16_bf16 v[32:47], v[104:107], v[12:15], v[32:47]
    ds_read_b128 v[104:107], v2 offset:29696
    v_mov_b32 v122, v182
    v_lshlrev_b32 v126, 2, v1
    s_lshl_b32 s92, s5, 10
    s_lshl_b32 s10, s3, 13
    s_add_u32 s92, s92, s10
    s_add_u32 s92, s92, 589824
    v_exp_f32 v52, v52
    v_exp_f32 v53, v53
    v_exp_f32 v54, v54
    v_exp_f32 v55, v55
    s_waitcnt lgkmcnt(3)
    v_mfma_f32_32x32x16_bf16 v[80:95], v[112:115], v[68:71], v[80:95]
    ds_read_b128 v[112:115], v2 offset:23552
    buffer_load_dword v127, v122, s[44:47], s53 offen
    v_cvt_pk_bf16_f32 v72, v48, v49
    v_cvt_pk_bf16_f32 v73, v50, v51
    v_cvt_pk_bf16_f32 v74, v52, v53
    v_cvt_pk_bf16_f32 v75, v54, v55
    v_exp_f32 v56, v56
    v_exp_f32 v57, v57
    v_smfmac_f32_16x16x64_bf16 v[96:99], v[116:119], v[64:71], v120
    s_waitcnt lgkmcnt(1)
    v_exp_f32 v58, v58
    v_exp_f32 v59, v59
    v_exp_f32 v60, v60
    v_exp_f32 v61, v61
    v_mfma_f32_32x32x16_bf16 v[80:95], v[108:111], v[72:75], v[80:95]
    ds_read_b128 v[108:111], v2 offset:26624
    v_exp_f32 v62, v62
    v_exp_f32 v63, v63
    s_setprio 3
    v_cvt_pk_bf16_f32 v76, v56, v57
    v_cvt_pk_bf16_f32 v77, v58, v59
    v_cvt_pk_bf16_f32 v78, v60, v61
    v_cvt_pk_bf16_f32 v79, v62, v63
    v_mfma_f32_32x32x16_bf16 v[48:63], v[100:103], v[8:11], v[16:31]
    s_waitcnt vmcnt(7)
    s_barrier
    ds_read_b128 v[100:103], v2 offset:32768
    v_exp_f32 v32, v32
    v_exp_f32 v33, v33
    v_exp_f32 v34, v34
    v_exp_f32 v35, v35
    v_mfma_f32_32x32x16_bf16 v[48:63], v[104:107], v[12:15], v[48:63]
    ds_read_b128 v[104:107], v2 offset:33792
    s_cmp_eq_u32 s3, 3
    s_cbranch_scc0 L_rx_121
    v_and_b32 v124, 31, v1
    v_lshlrev_b32 v123, 5, v124
    v_add_u32 v123, 156672, v123
    ds_read_b128 v[224:227], v123
    ds_read_b128 v[228:231], v123 offset:16
    v_lshlrev_b32 v124, 3, v124
    s_waitcnt lgkmcnt(0)
    v_add_f32 v224, v224, v225
    v_add_f32 v224, v224, v226
    v_add_f32 v224, v224, v227
    v_add_f32 v224, v224, v228
    v_add_f32 v224, v224, v229
    v_add_f32 v224, v224, v230
    v_add_f32 v224, v224, v231
    v_mov_b32 v225, 1
    s_mov_b32 exec_hi, 0
    buffer_store_dwordx2 v[224:225], v124, s[84:87], s94 offen sc1
    s_mov_b32 exec_hi, -1
L_rx_121:
    v_exp_f32 v36, v36
    v_exp_f32 v37, v37
    v_exp_f32 v38, v38
    v_exp_f32 v39, v39
    s_waitcnt lgkmcnt(3)
    v_mfma_f32_32x32x16_bf16 v[80:95], v[112:115], v[76:79], v[80:95]
    ds_read_b128 v[112:115], v2 offset:27648
    ds_read_b64_tr_b16 v[160:161], v5 offset:0
    ds_read_b64_tr_b16 v[162:163], v5 offset:1024
    ds_read_b64_tr_b16 v[164:165], v5 offset:8192
    ds_read_b64_tr_b16 v[166:167], v5 offset:9216
    v_cvt_pk_bf16_f32 v64, v32, v33
    v_cvt_pk_bf16_f32 v65, v34, v35
    v_cvt_pk_bf16_f32 v66, v36, v37
    v_cvt_pk_bf16_f32 v67, v38, v39
    v_exp_f32 v40, v40
    v_exp_f32 v41, v41
    v_smfmac_f32_16x16x64_bf16 v[96:99], v[116:119], v[72:79], v120
    s_waitcnt lgkmcnt(5)
    v_exp_f32 v42, v42
    v_exp_f32 v43, v43
    v_exp_f32 v44, v44
    v_exp_f32 v45, v45
    v_mfma_f32_32x32x16_bf16 v[80:95], v[108:111], v[64:67], v[80:95]
    ds_read_b128 v[108:111], v2 offset:30720
    ds_read_b64_tr_b16 v[168:169], v5 offset:16384
    ds_read_b64_tr_b16 v[170:171], v5 offset:17408
    ds_read_b64_tr_b16 v[172:173], v5 offset:24576
    ds_read_b64_tr_b16 v[174:175], v5 offset:25600
    v_exp_f32 v46, v46
    v_exp_f32 v47, v47
    s_setprio 2
    v_cvt_pk_bf16_f32 v68, v40, v41
    v_cvt_pk_bf16_f32 v69, v42, v43
    v_cvt_pk_bf16_f32 v70, v44, v45
    v_cvt_pk_bf16_f32 v71, v46, v47
    v_mfma_f32_32x32x16_bf16 v[32:47], v[100:103], v[8:11], v[16:31]
    ds_read_b128 v[100:103], v2 offset:36864
    v_exp_f32 v48, v48
    v_exp_f32 v49, v49
    v_exp_f32 v50, v50
    v_exp_f32 v51, v51
    v_mfma_f32_32x32x16_bf16 v[32:47], v[104:107], v[12:15], v[32:47]
    ds_read_b128 v[104:107], v2 offset:37888
    s_add_u32 m0, s98, 0
    s_and_b32 s55, s0, 0x3ffff
    buffer_load_dwordx4 v2, s[84:87], s55 offen offset:0 sc1 lds
    v_exp_f32 v52, v52
    v_exp_f32 v53, v53
    v_exp_f32 v54, v54
    v_exp_f32 v55, v55
    s_waitcnt lgkmcnt(11)
    v_mfma_f32_32x32x16_bf16 v[80:95], v[112:115], v[68:71], v[80:95]
    ds_read_b128 v[112:115], v2 offset:31744
    s_add_u32 m0, s98, 0
    s_add_u32 s0, s55, 16384
    buffer_load_dwordx4 v2, s[84:87], s55 offen offset:1024 sc1 lds
    v_cvt_pk_bf16_f32 v72, v48, v49
    v_cvt_pk_bf16_f32 v73, v50, v51
    v_cvt_pk_bf16_f32 v74, v52, v53
    v_cvt_pk_bf16_f32 v75, v54, v55
    v_exp_f32 v56, v56
    v_exp_f32 v57, v57
    v_smfmac_f32_16x16x64_bf16 v[96:99], v[116:119], v[64:71], v120
    s_waitcnt lgkmcnt(1)
    v_exp_f32 v58, v58
    v_exp_f32 v59, v59
    v_exp_f32 v60, v60
    v_exp_f32 v61, v61
    v_mfma_f32_32x32x16_bf16 v[80:95], v[108:111], v[72:75], v[80:95]
    ds_read_b128 v[108:111], v2 offset:34816
    v_exp_f32 v62, v62
    v_exp_f32 v63, v63
    s_setprio 1
    v_cvt_pk_bf16_f32 v76, v56, v57
    v_cvt_pk_bf16_f32 v77, v58, v59
    v_cvt_pk_bf16_f32 v78, v60, v61
    v_cvt_pk_bf16_f32 v79, v62, v63
    v_mfma_f32_32x32x16_bf16 v[48:63], v[100:103], v[8:11], v[16:31]
    ds_read_b128 v[100:103], v2 offset:40960
    v_exp_f32 v32, v32
    v_exp_f32 v33, v33
    v_exp_f32 v34, v34
    v_exp_f32 v35, v35
    v_mfma_f32_32x32x16_bf16 v[48:63], v[104:107], v[12:15], v[48:63]
    ds_read_b128 v[104:107], v2 offset:41984
    v_exp_f32 v36, v36
    v_exp_f32 v37, v37
    v_exp_f32 v38, v38
    v_exp_f32 v39, v39
    s_waitcnt lgkmcnt(3)
    v_mfma_f32_32x32x16_bf16 v[80:95], v[112:115], v[76:79], v[80:95]
    ds_read_b128 v[112:115], v2 offset:35840
    v_cvt_pk_bf16_f32 v64, v32, v33
    v_cvt_pk_bf16_f32 v65, v34, v35
    v_cvt_pk_bf16_f32 v66, v36, v37
    v_cvt_pk_bf16_f32 v67, v38, v39
    v_exp_f32 v40, v40
    v_exp_f32 v41, v41
    v_smfmac_f32_16x16x64_bf16 v[96:99], v[116:119], v[72:79], v120
    s_waitcnt lgkmcnt(1)
    v_exp_f32 v42, v42
    v_exp_f32 v43, v43
    v_exp_f32 v44, v44
    v_exp_f32 v45, v45
    v_mfma_f32_32x32x16_bf16 v[80:95], v[108:111], v[64:67], v[80:95]
    ds_read_b128 v[108:111], v2 offset:38912
    v_exp_f32 v46, v46
    v_exp_f32 v47, v47
    s_setprio 0
    v_cvt_pk_bf16_f32 v68, v40, v41
    v_cvt_pk_bf16_f32 v69, v42, v43
    v_cvt_pk_bf16_f32 v70, v44, v45
    v_cvt_pk_bf16_f32 v71, v46, v47
    v_mfma_f32_32x32x16_bf16 v[32:47], v[100:103], v[8:11], v[16:31]
    ds_read_b128 v[100:103], v2 offset:45056
    v_exp_f32 v48, v48
    v_exp_f32 v49, v49
    v_exp_f32 v50, v50
    v_exp_f32 v51, v51
    v_mfma_f32_32x32x16_bf16 v[32:47], v[104:107], v[12:15], v[32:47]
    ds_read_b128 v[104:107], v2 offset:46080
    v_exp_f32 v52, v52
    v_exp_f32 v53, v53
    v_exp_f32 v54, v54
    v_exp_f32 v55, v55
    s_waitcnt lgkmcnt(3)
    v_mfma_f32_32x32x16_bf16 v[80:95], v[112:115], v[68:71], v[80:95]
    ds_read_b128 v[112:115], v2 offset:39936
    v_cvt_pk_bf16_f32 v72, v48, v49
    v_cvt_pk_bf16_f32 v73, v50, v51
    v_cvt_pk_bf16_f32 v74, v52, v53
    v_cvt_pk_bf16_f32 v75, v54, v55
    v_exp_f32 v56, v56
    v_exp_f32 v57, v57
    v_smfmac_f32_16x16x64_bf16 v[96:99], v[116:119], v[64:71], v120
    s_waitcnt lgkmcnt(1)
    v_exp_f32 v58, v58
    v_exp_f32 v59, v59
    v_exp_f32 v60, v60
    v_exp_f32 v61, v61
    v_mfma_f32_32x32x16_bf16 v[80:95], v[108:111], v[72:75], v[80:95]
    ds_read_b128 v[108:111], v2 offset:43008
    v_exp_f32 v62, v62
    v_exp_f32 v63, v63
    s_setprio 3
    v_cvt_pk_bf16_f32 v76, v56, v57
    v_cvt_pk_bf16_f32 v77, v58, v59
    v_cvt_pk_bf16_f32 v78, v60, v61
    v_cvt_pk_bf16_f32 v79, v62, v63
    v_mfma_f32_32x32x16_bf16 v[48:63], v[100:103], v[8:11], v[16:31]
    s_waitcnt vmcnt(4)
    s_cmp_eq_u32 s3, 3
    s_cbranch_scc1 L_we_123
    s_waitcnt vmcnt(3)
L_we_123:
    s_barrier
    ds_read_b128 v[100:103], v2 offset:49152
    v_exp_f32 v32, v32
    v_exp_f32 v33, v33
    v_exp_f32 v34, v34
    v_exp_f32 v35, v35
    v_mfma_f32_32x32x16_bf16 v[48:63], v[104:107], v[12:15], v[48:63]
    ds_read_b128 v[104:107], v2 offset:50176
    ds_read_b64_tr_b16 v[176:177], v5 offset:32768
    ds_read_b64_tr_b16 v[178:179], v5 offset:33792
    ds_read_b64_tr_b16 v[180:181], v5 offset:40960
    ds_read_b64_tr_b16 v[182:183], v5 offset:41984
    v_exp_f32 v36, v36
    v_exp_f32 v37, v37
    v_exp_f32 v38, v38
    v_exp_f32 v39, v39
    s_waitcnt lgkmcnt(7)
    v_mfma_f32_32x32x16_bf16 v[80:95], v[112:115], v[76:79], v[80:95]
    ds_read_b128 v[112:115], v2 offset:44032
    ds_read_b64_tr_b16 v[184:185], v5 offset:49152
    ds_read_b64_tr_b16 v[186:187], v5 offset:50176
    ds_read_b64_tr_b16 v[188:189], v5 offset:57344
    ds_read_b64_tr_b16 v[190:191], v5 offset:58368
    v_cvt_pk_bf16_f32 v64, v32, v33
    v_cvt_pk_bf16_f32 v65, v34, v35
    v_cvt_pk_bf16_f32 v66, v36, v37
    v_cvt_pk_bf16_f32 v67, v38, v39
    v_exp_f32 v40, v40
    v_exp_f32 v41, v41
    v_smfmac_f32_16x16x64_bf16 v[96:99], v[116:119], v[72:79], v120
    s_waitcnt lgkmcnt(9)
    v_exp_f32 v42, v42
    v_exp_f32 v43, v43
    v_exp_f32 v44, v44
    v_exp_f32 v45, v45
    v_mfma_f32_32x32x16_bf16 v[80:95], v[108:111], v[64:67], v[80:95]
    ds_read_b128 v[108:111], v2 offset:47104
    s_add_u32 m0, s98, 65536
    s_and_b32 s27, s1, 0x1fffff
    buffer_load_dwordx4 v121, s[56:59], s27 offen lds
    v_exp_f32 v46, v46
    v_exp_f32 v47, v47
    s_setprio 2
    v_cvt_pk_bf16_f32 v68, v40, v41
    v_cvt_pk_bf16_f32 v69, v42, v43
    v_cvt_pk_bf16_f32 v70, v44, v45
    v_cvt_pk_bf16_f32 v71, v46, v47
    v_mfma_f32_32x32x16_bf16 v[32:47], v[100:103], v[8:11], v[16:31]
    ds_read_b128 v[100:103], v2 offset:53248
    v_exp_f32 v48, v48
    v_exp_f32 v49, v49
    v_exp_f32 v50, v50
    v_exp_f32 v51, v51
    v_mfma_f32_32x32x16_bf16 v[32:47], v[104:107], v[12:15], v[32:47]
    ds_read_b128 v[104:107], v2 offset:54272
    s_add_u32 m0, s98, 66560
    s_add_u32 s1, s27, 0x20000
    buffer_load_dwordx4 v125, s[56:59], s27 offen lds
    v_exp_f32 v52, v52
    v_exp_f32 v53, v53
    v_exp_f32 v54, v54
    v_exp_f32 v55, v55
    s_waitcnt lgkmcnt(7)
    v_mfma_f32_32x32x16_bf16 v[80:95], v[112:115], v[68:71], v[80:95]
    ds_read_b128 v[112:115], v2 offset:48128
    s_add_u32 m0, s98, 81920
    s_and_b32 s27, s1, 0x1fffff
    buffer_load_dwordx4 v121, s[56:59], s27 offen lds
    v_cvt_pk_bf16_f32 v72, v48, v49
    v_cvt_pk_bf16_f32 v73, v50, v51
    v_cvt_pk_bf16_f32 v74, v52, v53
    v_cvt_pk_bf16_f32 v75, v54, v55
    v_exp_f32 v56, v56
    v_exp_f32 v57, v57
    v_smfmac_f32_16x16x64_bf16 v[96:99], v[116:119], v[64:71], v120
    s_waitcnt lgkmcnt(1)
    v_exp_f32 v58, v58
    v_exp_f32 v59, v59
    v_exp_f32 v60, v60
    v_exp_f32 v61, v61
    v_mfma_f32_32x32x16_bf16 v[80:95], v[108:111], v[72:75], v[80:95]
    ds_read_b128 v[108:111], v2 offset:51200
    s_add_u32 m0, s98, 82944
    s_add_u32 s1, s27, 0x20000
    buffer_load_dwordx4 v125, s[56:59], s27 offen lds
    v_exp_f32 v62, v62
    v_exp_f32 v63, v63
    s_setprio 1
    v_cvt_pk_bf16_f32 v76, v56, v57
    v_cvt_pk_bf16_f32 v77, v58, v59
    v_cvt_pk_bf16_f32 v78, v60, v61
    v_cvt_pk_bf16_f32 v79, v62, v63
    v_mfma_f32_32x32x16_bf16 v[48:63], v[100:103], v[8:11], v[16:31]
    ds_read_b128 v[100:103], v2 offset:57344
    v_exp_f32 v32, v32
    v_exp_f32 v33, v33
    v_exp_f32 v34, v34
    v_exp_f32 v35, v35
    v_mfma_f32_32x32x16_bf16 v[48:63], v[104:107], v[12:15], v[48:63]
    ds_read_b128 v[104:107], v2 offset:58368
    s_add_u32 m0, s98, 16384
    s_and_b32 s55, s0, 0x3ffff
    buffer_load_dwordx4 v2, s[84:87], s55 offen offset:0 sc1 lds
    v_exp_f32 v36, v36
    v_exp_f32 v37, v37
    v_exp_f32 v38, v38
    v_exp_f32 v39, v39
    s_waitcnt lgkmcnt(3)
    v_mfma_f32_32x32x16_bf16 v[80:95], v[112:115], v[76:79], v[80:95]
    ds_read_b128 v[112:115], v2 offset:52224
    s_add_u32 m0, s98, 16384
    s_add_u32 s0, s55, 16384
    buffer_load_dwordx4 v2, s[84:87], s55 offen offset:1024 sc1 lds
    v_cvt_pk_bf16_f32 v64, v32, v33
    v_cvt_pk_bf16_f32 v65, v34, v35
    v_cvt_pk_bf16_f32 v66, v36, v37
    v_cvt_pk_bf16_f32 v67, v38, v39
    v_exp_f32 v40, v40
    v_exp_f32 v41, v41
    v_smfmac_f32_16x16x64_bf16 v[96:99], v[116:119], v[72:79], v120
    s_waitcnt lgkmcnt(1)
    v_exp_f32 v42, v42
    v_exp_f32 v43, v43
    v_exp_f32 v44, v44
    v_exp_f32 v45, v45
    v_mfma_f32_32x32x16_bf16 v[80:95], v[108:111], v[64:67], v[80:95]
    ds_read_b128 v[108:111], v2 offset:55296
    s_cmp_eq_u32 s3, 0
    s_cbranch_scc0 L_rx_126
    s_lshl_b32 s10, s4, 8
    s_add_u32 s10, s10, 1572864
    buffer_load_dword v240, v126, s[84:87], s10 offen sc1
L_rx_126:
    v_exp_f32 v46, v46
    v_exp_f32 v47, v47
    s_setprio 0
    v_cvt_pk_bf16_f32 v68, v40, v41
    v_cvt_pk_bf16_f32 v69, v42, v43
    v_cvt_pk_bf16_f32 v70, v44, v45
    v_cvt_pk_bf16_f32 v71, v46, v47
    v_mfma_f32_32x32x16_bf16 v[32:47], v[100:103], v[8:11], v[16:31]
    ds_read_b128 v[100:103], v2 offset:61440
    v_exp_f32 v48, v48
    v_exp_f32 v49, v49
    v_exp_f32 v50, v50
    v_exp_f32 v51, v51
    v_mfma_f32_32x32x16_bf16 v[32:47], v[104:107], v[12:15], v[32:47]
    ds_read_b128 v[104:107], v2 offset:62464
    v_exp_f32 v52, v52
    v_exp_f32 v53, v53
    v_exp_f32 v54, v54
    v_exp_f32 v55, v55
    s_waitcnt lgkmcnt(3)
    v_mfma_f32_32x32x16_bf16 v[80:95], v[112:115], v[68:71], v[80:95]
    ds_read_b128 v[112:115], v2 offset:56320
    v_cvt_pk_bf16_f32 v72, v48, v49
    v_cvt_pk_bf16_f32 v73, v50, v51
    v_cvt_pk_bf16_f32 v74, v52, v53
    v_cvt_pk_bf16_f32 v75, v54, v55
    v_exp_f32 v56, v56
    v_exp_f32 v57, v57
    v_smfmac_f32_16x16x64_bf16 v[96:99], v[116:119], v[64:71], v120
    s_waitcnt lgkmcnt(1)
    v_exp_f32 v58, v58
    v_exp_f32 v59, v59
    v_exp_f32 v60, v60
    v_exp_f32 v61, v61
    v_mfma_f32_32x32x16_bf16 v[80:95], v[108:111], v[72:75], v[80:95]
    ds_read_b128 v[108:111], v2 offset:59392
    v_exp_f32 v62, v62
    v_exp_f32 v63, v63
    s_setprio 3
    v_cvt_pk_bf16_f32 v76, v56, v57
    v_cvt_pk_bf16_f32 v77, v58, v59
    v_cvt_pk_bf16_f32 v78, v60, v61
    v_cvt_pk_bf16_f32 v79, v62, v63
    v_mfma_f32_32x32x16_bf16 v[48:63], v[100:103], v[8:11], v[16:31]
    s_waitcnt vmcnt(7)
    s_cmp_eq_u32 s3, 0
    s_cbranch_scc1 L_we_128
    s_waitcnt vmcnt(6)
L_we_128:
    s_barrier
    ds_read_b128 v[100:103], v2 offset:0
    v_exp_f32 v32, v32
    v_exp_f32 v33, v33
    v_exp_f32 v34, v34
    v_exp_f32 v35, v35
    v_mfma_f32_32x32x16_bf16 v[48:63], v[104:107], v[12:15], v[48:63]
    ds_read_b128 v[104:107], v2 offset:1024
    s_cmp_lg_u32 s89, 0
    s_cbranch_scc0 L_rx_131
    buffer_load_dwordx4 v[224:227], v2, s[84:87], s92 offen sc1
L_rx_131:
    v_exp_f32 v36, v36
    v_exp_f32 v37, v37
    v_exp_f32 v38, v38
    v_exp_f32 v39, v39
    s_waitcnt lgkmcnt(3)
    v_mfma_f32_32x32x16_bf16 v[80:95], v[112:115], v[76:79], v[80:95]
    ds_read_b128 v[112:115], v2 offset:60416
    s_add_u32 m0, s98, 98304
    s_and_b32 s27, s1, 0x1fffff
    buffer_load_dwordx4 v121, s[56:59], s27 offen lds
    v_cvt_pk_bf16_f32 v64, v32, v33
    v_cvt_pk_bf16_f32 v65, v34, v35
    v_cvt_pk_bf16_f32 v66, v36, v37
    v_cvt_pk_bf16_f32 v67, v38, v39
    v_exp_f32 v40, v40
    v_exp_f32 v41, v41
    v_smfmac_f32_16x16x64_bf16 v[96:99], v[116:119], v[72:79], v120
    s_waitcnt lgkmcnt(1)
    v_exp_f32 v42, v42
    v_exp_f32 v43, v43
    v_exp_f32 v44, v44
    v_exp_f32 v45, v45
    v_mfma_f32_32x32x16_bf16 v[80:95], v[108:111], v[64:67], v[80:95]
    ds_read_b128 v[108:111], v2 offset:63488
    s_add_u32 m0, s98, 99328
    s_add_u32 s1, s27, 0x20000
    buffer_load_dwordx4 v125, s[56:59], s27 offen lds
    v_exp_f32 v46, v46
    v_exp_f32 v47, v47
    s_setprio 2
    v_cvt_pk_bf16_f32 v68, v40, v41
    v_cvt_pk_bf16_f32 v69, v42, v43
    v_cvt_pk_bf16_f32 v70, v44, v45
    v_cvt_pk_bf16_f32 v71, v46, v47
    v_mfma_f32_32x32x16_bf16 v[32:47], v[100:103], v[8:11], v[16:31]
    ds_read_b128 v[100:103], v2 offset:4096
    v_exp_f32 v48, v48
    v_exp_f32 v49, v49
    v_exp_f32 v50, v50
    v_exp_f32 v51, v51
    v_mfma_f32_32x32x16_bf16 v[32:47], v[104:107], v[12:15], v[32:47]
    ds_read_b128 v[104:107], v2 offset:5120
    s_add_u32 m0, s98, 114688
    s_and_b32 s27, s1, 0x1fffff
    buffer_load_dwordx4 v121, s[56:59], s27 offen lds
    v_exp_f32 v52, v52
    v_exp_f32 v53, v53
    v_exp_f32 v54, v54
    v_exp_f32 v55, v55
    s_waitcnt lgkmcnt(3)
    v_mfma_f32_32x32x16_bf16 v[80:95], v[112:115], v[68:71], v[80:95]
    ds_read_b128 v[112:115], v2 offset:64512
    s_add_u32 m0, s98, 115712
    s_add_u32 s1, s27, 0x20000
    buffer_load_dwordx4 v125, s[56:59], s27 offen lds
    v_cvt_pk_bf16_f32 v72, v48, v49
    v_cvt_pk_bf16_f32 v73, v50, v51
    v_cvt_pk_bf16_f32 v74, v52, v53
    v_cvt_pk_bf16_f32 v75, v54, v55
    v_exp_f32 v56, v56
    v_exp_f32 v57, v57
    v_smfmac_f32_16x16x64_bf16 v[96:99], v[116:119], v[64:71], v120
    s_waitcnt lgkmcnt(1)
    v_exp_f32 v58, v58
    v_exp_f32 v59, v59
    v_exp_f32 v60, v60
    v_exp_f32 v61, v61
    v_mfma_f32_32x32x16_bf16 v[80:95], v[108:111], v[72:75], v[80:95]
    ds_read_b128 v[108:111], v2 offset:2048
    s_add_u32 m0, s98, 32768
    s_and_b32 s55, s0, 0x3ffff
    buffer_load_dwordx4 v2, s[84:87], s55 offen offset:0 sc1 lds
    v_exp_f32 v62, v62
    v_exp_f32 v63, v63
    s_setprio 1
    v_cvt_pk_bf16_f32 v76, v56, v57
    v_cvt_pk_bf16_f32 v77, v58, v59
    v_cvt_pk_bf16_f32 v78, v60, v61
    v_cvt_pk_bf16_f32 v79, v62, v63
    v_mfma_f32_32x32x16_bf16 v[48:63], v[100:103], v[8:11], v[16:31]
    ds_read_b128 v[100:103], v2 offset:8192
    v_exp_f32 v32, v32
    v_exp_f32 v33, v33
    v_exp_f32 v34, v34
    v_exp_f32 v35, v35
    v_mfma_f32_32x32x16_bf16 v[48:63], v[104:107], v[12:15], v[48:63]
    ds_read_b128 v[104:107], v2 offset:9216
    s_add_u32 m0, s98, 32768
    s_add_u32 s0, s55, 16384
    buffer_load_dwordx4 v2, s[84:87], s55 offen offset:1024 sc1 lds
    v_exp_f32 v36, v36
    v_exp_f32 v37, v37
    v_exp_f32 v38, v38
    v_exp_f32 v39, v39
    s_waitcnt lgkmcnt(3)
    v_mfma_f32_32x32x16_bf16 v[80:95], v[112:115], v[76:79], v[80:95]
    ds_read_b128 v[112:115], v2 offset:3072
    v_cvt_pk_bf16_f32 v64, v32, v33
    v_cvt_pk_bf16_f32 v65, v34, v35
    v_cvt_pk_bf16_f32 v66, v36, v37
    v_cvt_pk_bf16_f32 v67, v38, v39
    v_exp_f32 v40, v40
    v_exp_f32 v41, v41
    v_smfmac_f32_16x16x64_bf16 v[96:99], v[116:119], v[72:79], v120
    s_waitcnt lgkmcnt(1)
    v_exp_f32 v42, v42
    v_exp_f32 v43, v43
    v_exp_f32 v44, v44
    v_exp_f32 v45, v45
    v_mfma_f32_32x32x16_bf16 v[80:95], v[108:111], v[64:67], v[80:95]
    ds_read_b128 v[108:111], v2 offset:6144
    v_exp_f32 v46, v46
    v_exp_f32 v47, v47
    s_setprio 0
    v_cvt_pk_bf16_f32 v68, v40, v41
    v_cvt_pk_bf16_f32 v69, v42, v43
    v_cvt_pk_bf16_f32 v70, v44, v45
    v_cvt_pk_bf16_f32 v71, v46, v47
    v_mfma_f32_32x32x16_bf16 v[32:47], v[100:103], v[8:11], v[16:31]
    ds_read_b128 v[100:103], v2 offset:12288
    v_exp_f32 v48, v48
    v_exp_f32 v49, v49
    v_exp_f32 v50, v50
    v_exp_f32 v51, v51
    v_mfma_f32_32x32x16_bf16 v[32:47], v[104:107], v[12:15], v[32:47]
    ds_read_b128 v[104:107], v2 offset:13312
    v_exp_f32 v52, v52
    v_exp_f32 v53, v53
    v_exp_f32 v54, v54
    v_exp_f32 v55, v55
    s_waitcnt lgkmcnt(3)
    v_mfma_f32_32x32x16_bf16 v[80:95], v[112:115], v[68:71], v[80:95]
    ds_read_b128 v[112:115], v2 offset:7168
    s_cmp_lg_u32 s89, 0
    s_cbranch_scc0 L_rx_135
    s_waitcnt vmcnt(6)
    s_mov_b32 s99, 200000
L_poll_138:
    v_and_b32 v123, v225, v227
    v_cmp_ne_u32 vcc, 1, v123
    s_nop 0
    s_cbranch_vccz L_ok_137
    buffer_load_dwordx4 v[224:227], v2, s[84:87], s92 offen sc1
    s_waitcnt vmcnt(0)
    s_sub_u32 s99, s99, 1
    s_cbranch_scc0 L_poll_138
L_ok_137:
    s_lshl_b32 s10, s3, 2
    s_add_u32 s10, s10, 151552
    v_lshl_add_u32 v123, v1, 6, s10
    ds_write_b32 v123, v224
    ds_write_b32 v123, v226 offset:32
    s_waitcnt lgkmcnt(0)
L_rx_135:
    v_cvt_pk_bf16_f32 v72, v48, v49
    v_cvt_pk_bf16_f32 v73, v50, v51
    v_cvt_pk_bf16_f32 v74, v52, v53
    v_cvt_pk_bf16_f32 v75, v54, v55
    v_exp_f32 v56, v56
    v_exp_f32 v57, v57
    v_smfmac_f32_16x16x64_bf16 v[96:99], v[116:119], v[64:71], v120
    s_waitcnt lgkmcnt(1)
    v_exp_f32 v58, v58
    v_exp_f32 v59, v59
    v_exp_f32 v60, v60
    v_exp_f32 v61, v61
    v_mfma_f32_32x32x16_bf16 v[80:95], v[108:111], v[72:75], v[80:95]
    ds_read_b128 v[108:111], v2 offset:10240
    v_exp_f32 v62, v62
    v_exp_f32 v63, v63
    s_setprio 3
    v_cvt_pk_bf16_f32 v76, v56, v57
    v_cvt_pk_bf16_f32 v77, v58, v59
    v_cvt_pk_bf16_f32 v78, v60, v61
    v_cvt_pk_bf16_f32 v79, v62, v63
    v_mfma_f32_32x32x16_bf16 v[48:63], v[100:103], v[8:11], v[16:31]
    s_cmp_eq_u32 s3, 0
    s_cbranch_scc0 L_rx_141
    s_waitcnt vmcnt(6)
    v_cmp_ne_u32 vcc, 1, v240
    s_nop 0
    s_cbranch_vccz L_rx_141
    s_lshl_b32 s10, s4, 8
    s_add_u32 s10, s10, 1572864
    s_mov_b32 s99, 200000
L_poll_143:
    buffer_load_dword v240, v126, s[84:87], s10 offen sc1
    s_waitcnt vmcnt(0)
    v_cmp_ne_u32 vcc, 1, v240
    s_sub_u32 s99, s99, 1
    s_cbranch_scc1 L_rx_141
    s_cbranch_vccnz L_poll_143
L_rx_141:
    s_cmp_lg_u32 s89, 0
    s_cbranch_scc1 L_wd_145
    s_cmp_eq_u32 s3, 0
    s_cbranch_scc1 L_wd_146
    s_waitcnt vmcnt(6)
L_we_144:
    s_barrier
    ds_read_b128 v[100:103], v2 offset:16384
    v_exp_f32 v32, v32
    v_exp_f32 v33, v33
    v_exp_f32 v34, v34
    v_exp_f32 v35, v35
    v_mfma_f32_32x32x16_bf16 v[48:63], v[104:107], v[12:15], v[48:63]
    ds_read_b128 v[104:107], v2 offset:17408
    s_cmp_lg_u32 s89, 0
    s_cbranch_scc0 L_rx_149
    s_cmp_ge_u32 s3, 2
    s_cbranch_scc1 L_j_151
    v_lshlrev_b32 v123, 5, v0
    v_add_u32 v123, 151552, v123
    ds_read_b128 v[224:227], v123
    ds_read_b128 v[228:231], v123 offset:16
    v_mov_b32 v232, s96
    v_mul_f32 v232, 0xbfb8aa3b, v232
    v_exp_f32 v232, v232
    s_nop 0
    v_add_f32 v232, 1.0, v232
    v_rcp_f32 v232, v232
    s_nop 0
    v_cvt_pk_bf16_f32 v232, v232, v232
    v_and_b32 v232, 0xffff0000, v232
    v_lshlrev_b32 v123, 2, v0
    v_add_u32 v123, 149760, v123
    s_waitcnt lgkmcnt(0)
    v_add_f32 v224, v224, v225
    v_add_f32 v224, v224, v226
    v_add_f32 v224, v224, v227
    v_add_f32 v224, v224, v228
    v_add_f32 v224, v224, v229
    v_add_f32 v224, v224, v230
    v_add_f32 v224, v224, v231
    v_cvt_pk_bf16_f32 v224, v224, v224
    v_and_b32 v224, 0xffff0000, v224
    v_mul_f32 v224, v224, v232
    v_cvt_pk_bf16_f32 v224, v224, v224
    v_and_b32 v224, 0xffff0000, v224
    ds_write_b32 v123, v224
    s_waitcnt lgkmcnt(0)
L_j_151:
L_rx_149:
    v_exp_f32 v36, v36
    v_exp_f32 v37, v37
    v_exp_f32 v38, v38
    v_exp_f32 v39, v39
    s_waitcnt lgkmcnt(3)
    v_mfma_f32_32x32x16_bf16 v[80:95], v[112:115], v[76:79], v[80:95]
    ds_read_b128 v[112:115], v2 offset:11264
    ds_read_b64_tr_b16 v[192:193], v5 offset:0
    ds_read_b64_tr_b16 v[194:195], v5 offset:1024
    ds_read_b64_tr_b16 v[196:197], v5 offset:8192
    ds_read_b64_tr_b16 v[198:199], v5 offset:9216
    v_cvt_pk_bf16_f32 v64, v32, v33
    v_cvt_pk_bf16_f32 v65, v34, v35
    v_cvt_pk_bf16_f32 v66, v36, v37
    v_cvt_pk_bf16_f32 v67, v38, v39
    v_exp_f32 v40, v40
    v_exp_f32 v41, v41
    v_smfmac_f32_16x16x64_bf16 v[96:99], v[116:119], v[72:79], v120
    s_waitcnt lgkmcnt(5)
    v_exp_f32 v42, v42
    v_exp_f32 v43, v43
    v_exp_f32 v44, v44
    v_exp_f32 v45, v45
    v_mfma_f32_32x32x16_bf16 v[80:95], v[108:111], v[64:67], v[80:95]
    ds_read_b128 v[108:111], v2 offset:14336
    ds_read_b64_tr_b16 v[200:201], v5 offset:16384
    ds_read_b64_tr_b16 v[202:203], v5 offset:17408
    ds_read_b64_tr_b16 v[204:205], v5 offset:24576
    ds_read_b64_tr_b16 v[206:207], v5 offset:25600
    v_exp_f32 v46, v46
    v_exp_f32 v47, v47
    s_setprio 2
    v_cvt_pk_bf16_f32 v68, v40, v41
    v_cvt_pk_bf16_f32 v69, v42, v43
    v_cvt_pk_bf16_f32 v70, v44, v45
    v_cvt_pk_bf16_f32 v71, v46, v47
    v_mfma_f32_32x32x16_bf16 v[32:47], v[100:103], v[8:11], v[16:31]
    ds_read_b128 v[100:103], v2 offset:20480
    v_exp_f32 v48, v48
    v_exp_f32 v49, v49
    v_exp_f32 v50, v50
    v_exp_f32 v51, v51
    v_mfma_f32_32x32x16_bf16 v[32:47], v[104:107], v[12:15], v[32:47]
    ds_read_b128 v[104:107], v2 offset:21504
    s_add_u32 m0, s98, 49152
    s_and_b32 s55, s0, 0x3ffff
    buffer_load_dwordx4 v2, s[84:87], s55 offen offset:0 sc1 lds
    v_exp_f32 v52, v52
    v_exp_f32 v53, v53
    v_exp_f32 v54, v54
    v_exp_f32 v55, v55
    s_waitcnt lgkmcnt(11)
    v_mfma_f32_32x32x16_bf16 v[80:95], v[112:115], v[68:71], v[80:95]
    ds_read_b128 v[112:115], v2 offset:15360
    s_add_u32 m0, s98, 49152
    s_add_u32 s0, s55, 16384
    buffer_load_dwordx4 v2, s[84:87], s55 offen offset:1024 sc1 lds
    v_cvt_pk_bf16_f32 v72, v48, v49
    v_cvt_pk_bf16_f32 v73, v50, v51
    v_cvt_pk_bf16_f32 v74, v52, v53
    v_cvt_pk_bf16_f32 v75, v54, v55
    v_exp_f32 v56, v56
    v_exp_f32 v57, v57
    v_smfmac_f32_16x16x64_bf16 v[96:99], v[116:119], v[64:71], v120
    s_waitcnt lgkmcnt(1)
    v_exp_f32 v58, v58
    v_exp_f32 v59, v59
    v_exp_f32 v60, v60
    v_exp_f32 v61, v61
    v_mfma_f32_32x32x16_bf16 v[80:95], v[108:111], v[72:75], v[80:95]
    ds_read_b128 v[108:111], v2 offset:18432
    v_exp_f32 v62, v62
    v_exp_f32 v63, v63
    s_setprio 1
    v_cvt_pk_bf16_f32 v76, v56, v57
    v_cvt_pk_bf16_f32 v77, v58, v59
    v_cvt_pk_bf16_f32 v78, v60, v61
    v_cvt_pk_bf16_f32 v79, v62, v63
    v_mfma_f32_32x32x16_bf16 v[48:63], v[100:103], v[8:11], v[16:31]
    ds_read_b128 v[100:103], v2 offset:24576
    v_exp_f32 v32, v32
    v_exp_f32 v33, v33
    v_exp_f32 v34, v34
    v_exp_f32 v35, v35
    v_mfma_f32_32x32x16_bf16 v[48:63], v[104:107], v[12:15], v[48:63]
    ds_read_b128 v[104:107], v2 offset:25600
    v_exp_f32 v36, v36
    v_exp_f32 v37, v37
    v_exp_f32 v38, v38
    v_exp_f32 v39, v39
    s_waitcnt lgkmcnt(3)
    v_mfma_f32_32x32x16_bf16 v[80:95], v[112:115], v[76:79], v[80:95]
    ds_read_b128 v[112:115], v2 offset:19456
    v_cvt_pk_bf16_f32 v64, v32, v33
    v_cvt_pk_bf16_f32 v65, v34, v35
    v_cvt_pk_bf16_f32 v66, v36, v37
    v_cvt_pk_bf16_f32 v67, v38, v39
    v_exp_f32 v40, v40
    v_exp_f32 v41, v41
    v_smfmac_f32_16x16x64_bf16 v[96:99], v[116:119], v[72:79], v120
    s_waitcnt lgkmcnt(1)
    v_exp_f32 v42, v42
    v_exp_f32 v43, v43
    v_exp_f32 v44, v44
    v_exp_f32 v45, v45
    v_mfma_f32_32x32x16_bf16 v[80:95], v[108:111], v[64:67], v[80:95]
    ds_read_b128 v[108:111], v2 offset:22528
    v_exp_f32 v46, v46
    v_exp_f32 v47, v47
    s_setprio 0
    v_cvt_pk_bf16_f32 v68, v40, v41
    v_cvt_pk_bf16_f32 v69, v42, v43
    v_cvt_pk_bf16_f32 v70, v44, v45
    v_cvt_pk_bf16_f32 v71, v46, v47
    v_mfma_f32_32x32x16_bf16 v[32:47], v[100:103], v[8:11], v[16:31]
    ds_read_b128 v[100:103], v2 offset:28672
    v_exp_f32 v48, v48
    v_exp_f32 v49, v49
    v_exp_f32 v50, v50
    v_exp_f32 v51, v51
    v_mfma_f32_32x32x16_bf16 v[32:47], v[104:107], v[12:15], v[32:47]
    ds_read_b128 v[104:107], v2 offset:29696
    v_exp_f32 v52, v52
    v_exp_f32 v53, v53
    v_exp_f32 v54, v54
    v_exp_f32 v55, v55
    s_waitcnt lgkmcnt(3)
    v_mfma_f32_32x32x16_bf16 v[80:95], v[112:115], v[68:71], v[80:95]
    ds_read_b128 v[112:115], v2 offset:23552
    v_cvt_pk_bf16_f32 v72, v48, v49
    v_cvt_pk_bf16_f32 v73, v50, v51
    v_cvt_pk_bf16_f32 v74, v52, v53
    v_cvt_pk_bf16_f32 v75, v54, v55
    v_exp_f32 v56, v56
    v_exp_f32 v57, v57
    v_smfmac_f32_16x16x64_bf16 v[96:99], v[116:119], v[64:71], v120
    s_waitcnt lgkmcnt(1)
    v_exp_f32 v58, v58
    v_exp_f32 v59, v59
    v_exp_f32 v60, v60
    v_exp_f32 v61, v61
    v_mfma_f32_32x32x16_bf16 v[80:95], v[108:111], v[72:75], v[80:95]
    ds_read_b128 v[108:111], v2 offset:26624
    v_exp_f32 v62, v62
    v_exp_f32 v63, v63
    s_setprio 3
    v_cvt_pk_bf16_f32 v76, v56, v57
    v_cvt_pk_bf16_f32 v77, v58, v59
    v_cvt_pk_bf16_f32 v78, v60, v61
    v_cvt_pk_bf16_f32 v79, v62, v63
    v_mfma_f32_32x32x16_bf16 v[48:63], v[100:103], v[8:11], v[16:31]
    s_waitcnt vmcnt(2)
    s_barrier
    ds_read_b128 v[100:103], v2 offset:32768
    v_exp_f32 v32, v32
    v_exp_f32 v33, v33
    v_exp_f32 v34, v34
    v_exp_f32 v35, v35
    v_mfma_f32_32x32x16_bf16 v[48:63], v[104:107], v[12:15], v[48:63]
    ds_read_b128 v[104:107], v2 offset:33792
    s_add_u32 m0, s98, 65536
    s_and_b32 s27, s1, 0x1fffff
    buffer_load_dwordx4 v121, s[56:59], s27 offen lds
    v_exp_f32 v36, v36
    v_exp_f32 v37, v37
    v_exp_f32 v38, v38
    v_exp_f32 v39, v39
    s_waitcnt lgkmcnt(3)
    v_mfma_f32_32x32x16_bf16 v[80:95], v[112:115], v[76:79], v[80:95]
    ds_read_b128 v[112:115], v2 offset:27648
    s_add_u32 m0, s98, 66560
    s_add_u32 s1, s27, 0x20000
    buffer_load_dwordx4 v125, s[56:59], s27 offen lds
    v_cvt_pk_bf16_f32 v64, v32, v33
    v_cvt_pk_bf16_f32 v65, v34, v35
    v_cvt_pk_bf16_f32 v66, v36, v37
    v_cvt_pk_bf16_f32 v67, v38, v39
    v_exp_f32 v40, v40
    v_exp_f32 v41, v41
    v_smfmac_f32_16x16x64_bf16 v[96:99], v[116:119], v[72:79], v120
    s_waitcnt lgkmcnt(1)
    v_exp_f32 v42, v42
    v_exp_f32 v43, v43
    v_exp_f32 v44, v44
    v_exp_f32 v45, v45
    v_mfma_f32_32x32x16_bf16 v[80:95], v[108:111], v[64:67], v[80:95]
    ds_read_b128 v[108:111], v2 offset:30720
    s_add_u32 m0, s98, 81920
    s_and_b32 s27, s1, 0x1fffff
    buffer_load_dwordx4 v121, s[56:59], s27 offen lds
    v_exp_f32 v46, v46
    v_exp_f32 v47, v47
    s_setprio 2
    v_cvt_pk_bf16_f32 v68, v40, v41
    v_cvt_pk_bf16_f32 v69, v42, v43
    v_cvt_pk_bf16_f32 v70, v44, v45
    v_cvt_pk_bf16_f32 v71, v46, v47
    v_mfma_f32_32x32x16_bf16 v[32:47], v[100:103], v[8:11], v[16:31]
    ds_read_b128 v[100:103], v2 offset:36864
    v_exp_f32 v48, v48
    v_exp_f32 v49, v49
    v_exp_f32 v50, v50
    v_exp_f32 v51, v51
    v_mfma_f32_32x32x16_bf16 v[32:47], v[104:107], v[12:15], v[32:47]
    ds_read_b128 v[104:107], v2 offset:37888
    s_add_u32 m0, s98, 82944
    s_add_u32 s1, s27, 0x20000
    buffer_load_dwordx4 v125, s[56:59], s27 offen lds
    v_exp_f32 v52, v52
    v_exp_f32 v53, v53
    v_exp_f32 v54, v54
    v_exp_f32 v55, v55
    s_waitcnt lgkmcnt(3)
    v_mfma_f32_32x32x16_bf16 v[80:95], v[112:115], v[68:71], v[80:95]
    ds_read_b128 v[112:115], v2 offset:31744
    ds_read_b64_tr_b16 v[208:209], v5 offset:32768
    ds_read_b64_tr_b16 v[210:211], v5 offset:33792
    ds_read_b64_tr_b16 v[212:213], v5 offset:40960
    ds_read_b64_tr_b16 v[214:215], v5 offset:41984
    v_cvt_pk_bf16_f32 v72, v48, v49
    v_cvt_pk_bf16_f32 v73, v50, v51
    v_cvt_pk_bf16_f32 v74, v52, v53
    v_cvt_pk_bf16_f32 v75, v54, v55
    v_exp_f32 v56, v56
    v_exp_f32 v57, v57
    v_smfmac_f32_16x16x64_bf16 v[96:99], v[116:119], v[64:71], v120
    s_waitcnt lgkmcnt(5)
    v_exp_f32 v58, v58
    v_exp_f32 v59, v59
    v_exp_f32 v60, v60
    v_exp_f32 v61, v61
    v_mfma_f32_32x32x16_bf16 v[80:95], v[108:111], v[72:75], v[80:95]
    ds_read_b128 v[108:111], v2 offset:34816
    ds_read_b64_tr_b16 v[216:217], v5 offset:49152
    ds_read_b64_tr_b16 v[218:219], v5 offset:50176
    ds_read_b64_tr_b16 v[220:221], v5 offset:57344
    ds_read_b64_tr_b16 v[222:223], v5 offset:58368
    v_exp_f32 v62, v62
    v_exp_f32 v63, v63
    s_setprio 1
    v_cvt_pk_bf16_f32 v76, v56, v57
    v_cvt_pk_bf16_f32 v77, v58, v59
    v_cvt_pk_bf16_f32 v78, v60, v61
    v_cvt_pk_bf16_f32 v79, v62, v63
    v_mfma_f32_32x32x16_bf16 v[48:63], v[100:103], v[8:11], v[16:31]
    ds_read_b128 v[100:103], v2 offset:40960
    v_exp_f32 v32, v32
    v_exp_f32 v33, v33
    v_exp_f32 v34, v34
    v_exp_f32 v35, v35
    v_mfma_f32_32x32x16_bf16 v[48:63], v[104:107], v[12:15], v[48:63]
    ds_read_b128 v[104:107], v2 offset:41984
    v_exp_f32 v36, v36
    v_exp_f32 v37, v37
    v_exp_f32 v38, v38
    v_exp_f32 v39, v39
    s_waitcnt lgkmcnt(11)
    v_mfma_f32_32x32x16_bf16 v[80:95], v[112:115], v[76:79], v[80:95]
    ds_read_b128 v[112:115], v2 offset:35840
    v_cvt_pk_bf16_f32 v64, v32, v33
    v_cvt_pk_bf16_f32 v65, v34, v35
    v_cvt_pk_bf16_f32 v66, v36, v37
    v_cvt_pk_bf16_f32 v67, v38, v39
    v_exp_f32 v40, v40
    v_exp_f32 v41, v41
    v_smfmac_f32_16x16x64_bf16 v[96:99], v[116:119], v[72:79], v120
    s_waitcnt lgkmcnt(1)
    v_exp_f32 v42, v42
    v_exp_f32 v43, v43
    v_exp_f32 v44, v44
    v_exp_f32 v45, v45
    v_mfma_f32_32x32x16_bf16 v[80:95], v[108:111], v[64:67], v[80:95]
    ds_read_b128 v[108:111], v2 offset:38912
    v_exp_f32 v46, v46
    v_exp_f32 v47, v47
    s_setprio 0
    v_cvt_pk_bf16_f32 v68, v40, v41
    v_cvt_pk_bf16_f32 v69, v42, v43
    v_cvt_pk_bf16_f32 v70, v44, v45
    v_cvt_pk_bf16_f32 v71, v46, v47
    v_mfma_f32_32x32x16_bf16 v[32:47], v[100:103], v[8:11], v[16:31]
    ds_read_b128 v[100:103], v2 offset:45056
    v_exp_f32 v48, v48
    v_exp_f32 v49, v49
    v_exp_f32 v50, v50
    v_exp_f32 v51, v51
    v_mfma_f32_32x32x16_bf16 v[32:47], v[104:107], v[12:15], v[32:47]
    ds_read_b128 v[104:107], v2 offset:46080
    v_exp_f32 v52, v52
    v_exp_f32 v53, v53
    v_exp_f32 v54, v54
    v_exp_f32 v55, v55
    s_waitcnt lgkmcnt(3)
    v_mfma_f32_32x32x16_bf16 v[80:95], v[112:115], v[68:71], v[80:95]
    ds_read_b128 v[112:115], v2 offset:39936
    v_cvt_pk_bf16_f32 v72, v48, v49
    v_cvt_pk_bf16_f32 v73, v50, v51
    v_cvt_pk_bf16_f32 v74, v52, v53
    v_cvt_pk_bf16_f32 v75, v54, v55
    v_exp_f32 v56, v56
    v_exp_f32 v57, v57
    v_smfmac_f32_16x16x64_bf16 v[96:99], v[116:119], v[64:71], v120
    s_waitcnt lgkmcnt(1)
    v_exp_f32 v58, v58
    v_exp_f32 v59, v59
    v_exp_f32 v60, v60
    v_exp_f32 v61, v61
    v_mfma_f32_32x32x16_bf16 v[80:95], v[108:111], v[72:75], v[80:95]
    ds_read_b128 v[108:111], v2 offset:43008
    v_exp_f32 v62, v62
    v_exp_f32 v63, v63
    s_setprio 3
    v_cvt_pk_bf16_f32 v76, v56, v57
    v_cvt_pk_bf16_f32 v77, v58, v59
    v_cvt_pk_bf16_f32 v78, v60, v61
    v_cvt_pk_bf16_f32 v79, v62, v63
    v_mfma_f32_32x32x16_bf16 v[48:63], v[100:103], v[8:11], v[16:31]
    s_waitcnt vmcnt(0)
    s_barrier
    ds_read_b128 v[100:103], v2 offset:49152
    v_exp_f32 v32, v32
    v_exp_f32 v33, v33
    v_exp_f32 v34, v34
    v_exp_f32 v35, v35
    v_mfma_f32_32x32x16_bf16 v[48:63], v[104:107], v[12:15], v[48:63]
    ds_read_b128 v[104:107], v2 offset:50176
    s_add_u32 m0, s98, 98304
    s_and_b32 s27, s1, 0x1fffff
    buffer_load_dwordx4 v121, s[56:59], s27 offen lds
    v_exp_f32 v36, v36
    v_exp_f32 v37, v37
    v_exp_f32 v38, v38
    v_exp_f32 v39, v39
    s_waitcnt lgkmcnt(3)
    v_mfma_f32_32x32x16_bf16 v[80:95], v[112:115], v[76:79], v[80:95]
    ds_read_b128 v[112:115], v2 offset:44032
    s_add_u32 m0, s98, 99328
    s_add_u32 s1, s27, 0x20000
    buffer_load_dwordx4 v125, s[56:59], s27 offen lds
    v_cvt_pk_bf16_f32 v64, v32, v33
    v_cvt_pk_bf16_f32 v65, v34, v35
    v_cvt_pk_bf16_f32 v66, v36, v37
    v_cvt_pk_bf16_f32 v67, v38, v39
    v_exp_f32 v40, v40
    v_exp_f32 v41, v41
    v_smfmac_f32_16x16x64_bf16 v[96:99], v[116:119], v[72:79], v120
    s_waitcnt lgkmcnt(1)
    v_exp_f32 v42, v42
    v_exp_f32 v43, v43
    v_exp_f32 v44, v44
    v_exp_f32 v45, v45
    v_mfma_f32_32x32x16_bf16 v[80:95], v[108:111], v[64:67], v[80:95]
    ds_read_b128 v[108:111], v2 offset:47104
    s_add_u32 m0, s98, 114688
    s_and_b32 s27, s1, 0x1fffff
    buffer_load_dwordx4 v121, s[56:59], s27 offen lds
    v_exp_f32 v46, v46
    v_exp_f32 v47, v47
    s_setprio 2
    v_cvt_pk_bf16_f32 v68, v40, v41
    v_cvt_pk_bf16_f32 v69, v42, v43
    v_cvt_pk_bf16_f32 v70, v44, v45
    v_cvt_pk_bf16_f32 v71, v46, v47
    v_mfma_f32_32x32x16_bf16 v[32:47], v[100:103], v[8:11], v[16:31]
    ds_read_b128 v[100:103], v2 offset:53248
    v_exp_f32 v48, v48
    v_exp_f32 v49, v49
    v_exp_f32 v50, v50
    v_exp_f32 v51, v51
    v_mfma_f32_32x32x16_bf16 v[32:47], v[104:107], v[12:15], v[32:47]
    ds_read_b128 v[104:107], v2 offset:54272
    s_add_u32 m0, s98, 115712
    s_add_u32 s1, s27, 0x20000
    buffer_load_dwordx4 v125, s[56:59], s27 offen lds
    v_exp_f32 v52, v52
    v_exp_f32 v53, v53
    v_exp_f32 v54, v54
    v_exp_f32 v55, v55
    s_waitcnt lgkmcnt(3)
    v_mfma_f32_32x32x16_bf16 v[80:95], v[112:115], v[68:71], v[80:95]
    ds_read_b128 v[112:115], v2 offset:48128
    ds_read_b64_tr_b16 v[224:225], v5 offset:0
    ds_read_b64_tr_b16 v[226:227], v5 offset:1024
    ds_read_b64_tr_b16 v[228:229], v5 offset:8192
    ds_read_b64_tr_b16 v[230:231], v5 offset:9216
    v_cvt_pk_bf16_f32 v72, v48, v49
    v_cvt_pk_bf16_f32 v73, v50, v51
    v_cvt_pk_bf16_f32 v74, v52, v53
    v_cvt_pk_bf16_f32 v75, v54, v55
    v_exp_f32 v56, v56
    v_exp_f32 v57, v57
    v_smfmac_f32_16x16x64_bf16 v[96:99], v[116:119], v[64:71], v120
    s_waitcnt lgkmcnt(5)
    v_exp_f32 v58, v58
    v_exp_f32 v59, v59
    v_exp_f32 v60, v60
    v_exp_f32 v61, v61
    v_mfma_f32_32x32x16_bf16 v[80:95], v[108:111], v[72:75], v[80:95]
    ds_read_b128 v[108:111], v2 offset:51200
    ds_read_b64_tr_b16 v[232:233], v5 offset:16384
    ds_read_b64_tr_b16 v[234:235], v5 offset:17408
    ds_read_b64_tr_b16 v[236:237], v5 offset:24576
    ds_read_b64_tr_b16 v[238:239], v5 offset:25600
    v_exp_f32 v62, v62
    v_exp_f32 v63, v63
    s_setprio 1
    v_cvt_pk_bf16_f32 v76, v56, v57
    v_cvt_pk_bf16_f32 v77, v58, v59
    v_cvt_pk_bf16_f32 v78, v60, v61
    v_cvt_pk_bf16_f32 v79, v62, v63
    v_mfma_f32_32x32x16_bf16 v[48:63], v[100:103], v[8:11], v[16:31]
    ds_read_b128 v[100:103], v2 offset:57344
    v_exp_f32 v32, v32
    v_exp_f32 v33, v33
    v_exp_f32 v34, v34
    v_exp_f32 v35, v35
    v_mfma_f32_32x32x16_bf16 v[48:63], v[104:107], v[12:15], v[48:63]
    ds_read_b128 v[104:107], v2 offset:58368
    v_exp_f32 v36, v36
    v_exp_f32 v37, v37
    v_exp_f32 v38, v38
    v_exp_f32 v39, v39
    s_waitcnt lgkmcnt(11)
    v_mfma_f32_32x32x16_bf16 v[80:95], v[112:115], v[76:79], v[80:95]
    ds_read_b128 v[112:115], v2 offset:52224
    v_cvt_pk_bf16_f32 v64, v32, v33
    v_cvt_pk_bf16_f32 v65, v34, v35
    v_cvt_pk_bf16_f32 v66, v36, v37
    v_cvt_pk_bf16_f32 v67, v38, v39
    v_exp_f32 v40, v40
    v_exp_f32 v41, v41
    v_smfmac_f32_16x16x64_bf16 v[96:99], v[116:119], v[72:79], v120
    s_waitcnt lgkmcnt(1)
    v_exp_f32 v42, v42
    v_exp_f32 v43, v43
    v_exp_f32 v44, v44
    v_exp_f32 v45, v45
    v_mfma_f32_32x32x16_bf16 v[80:95], v[108:111], v[64:67], v[80:95]
    ds_read_b128 v[108:111], v2 offset:55296
    v_exp_f32 v46, v46
    v_exp_f32 v47, v47
    s_setprio 0
    v_cvt_pk_bf16_f32 v68, v40, v41
    v_cvt_pk_bf16_f32 v69, v42, v43
    v_cvt_pk_bf16_f32 v70, v44, v45
    v_cvt_pk_bf16_f32 v71, v46, v47
    v_mfma_f32_32x32x16_bf16 v[32:47], v[100:103], v[8:11], v[16:31]
    ds_read_b128 v[100:103], v2 offset:61440
    v_exp_f32 v48, v48
    v_exp_f32 v49, v49
    v_exp_f32 v50, v50
    v_exp_f32 v51, v51
    v_mfma_f32_32x32x16_bf16 v[32:47], v[104:107], v[12:15], v[32:47]
    ds_read_b128 v[104:107], v2 offset:62464
    v_exp_f32 v52, v52
    v_exp_f32 v53, v53
    v_exp_f32 v54, v54
    v_exp_f32 v55, v55
    s_waitcnt lgkmcnt(3)
    v_mfma_f32_32x32x16_bf16 v[80:95], v[112:115], v[68:71], v[80:95]
    ds_read_b128 v[112:115], v2 offset:56320
    v_cvt_pk_bf16_f32 v72, v48, v49
    v_cvt_pk_bf16_f32 v73, v50, v51
    v_cvt_pk_bf16_f32 v74, v52, v53
    v_cvt_pk_bf16_f32 v75, v54, v55
    v_exp_f32 v56, v56
    v_exp_f32 v57, v57
    v_smfmac_f32_16x16x64_bf16 v[96:99], v[116:119], v[64:71], v120
    s_waitcnt lgkmcnt(1)
    v_exp_f32 v58, v58
    v_exp_f32 v59, v59
    v_exp_f32 v60, v60
    v_exp_f32 v61, v61
    v_mfma_f32_32x32x16_bf16 v[80:95], v[108:111], v[72:75], v[80:95]
    ds_read_b128 v[108:111], v2 offset:59392
    v_exp_f32 v62, v62
    v_exp_f32 v63, v63
    s_setprio 3
    v_cvt_pk_bf16_f32 v76, v56, v57
    v_cvt_pk_bf16_f32 v77, v58, v59
    v_cvt_pk_bf16_f32 v78, v60, v61
    v_cvt_pk_bf16_f32 v79, v62, v63
    v_mfma_f32_32x32x16_bf16 v[48:63], v[100:103], v[8:11], v[16:31]
    v_exp_f32 v32, v32
    v_exp_f32 v33, v33
    v_exp_f32 v34, v34
    v_exp_f32 v35, v35
    v_mfma_f32_32x32x16_bf16 v[48:63], v[104:107], v[12:15], v[48:63]
    v_exp_f32 v36, v36
    v_exp_f32 v37, v37
    v_exp_f32 v38, v38
    v_exp_f32 v39, v39
    s_waitcnt lgkmcnt(1)
    v_mfma_f32_32x32x16_bf16 v[80:95], v[112:115], v[76:79], v[80:95]
    ds_read_b128 v[112:115], v2 offset:60416
    v_cvt_pk_bf16_f32 v64, v32, v33
    v_cvt_pk_bf16_f32 v65, v34, v35
    v_cvt_pk_bf16_f32 v66, v36, v37
    v_cvt_pk_bf16_f32 v67, v38, v39
    v_exp_f32 v40, v40
    v_exp_f32 v41, v41
    v_smfmac_f32_16x16x64_bf16 v[96:99], v[116:119], v[72:79], v120
    s_waitcnt lgkmcnt(1)
    v_exp_f32 v42, v42
    v_exp_f32 v43, v43
    v_exp_f32 v44, v44
    v_exp_f32 v45, v45
    v_mfma_f32_32x32x16_bf16 v[80:95], v[108:111], v[64:67], v[80:95]
    ds_read_b128 v[108:111], v2 offset:63488
    v_exp_f32 v46, v46
    v_exp_f32 v47, v47
    s_setprio 2
    v_cvt_pk_bf16_f32 v68, v40, v41
    v_cvt_pk_bf16_f32 v69, v42, v43
    v_cvt_pk_bf16_f32 v70, v44, v45
    v_cvt_pk_bf16_f32 v71, v46, v47
    v_exp_f32 v48, v48
    v_exp_f32 v49, v49
    v_exp_f32 v50, v50
    v_exp_f32 v51, v51
    v_exp_f32 v52, v52
    v_exp_f32 v53, v53
    v_exp_f32 v54, v54
    v_exp_f32 v55, v55
    s_waitcnt lgkmcnt(1)
    v_mfma_f32_32x32x16_bf16 v[80:95], v[112:115], v[68:71], v[80:95]
    ds_read_b128 v[112:115], v2 offset:64512
    v_cvt_pk_bf16_f32 v72, v48, v49
    v_cvt_pk_bf16_f32 v73, v50, v51
    v_cvt_pk_bf16_f32 v74, v52, v53
    v_cvt_pk_bf16_f32 v75, v54, v55
    v_exp_f32 v56, v56
    v_exp_f32 v57, v57
    v_smfmac_f32_16x16x64_bf16 v[96:99], v[116:119], v[64:71], v120
    s_waitcnt lgkmcnt(1)
    v_exp_f32 v58, v58
    v_exp_f32 v59, v59
    v_exp_f32 v60, v60
    v_exp_f32 v61, v61
    v_mfma_f32_32x32x16_bf16 v[80:95], v[108:111], v[72:75], v[80:95]
    v_exp_f32 v62, v62
    v_exp_f32 v63, v63
    s_setprio 1
    v_cvt_pk_bf16_f32 v76, v56, v57
    v_cvt_pk_bf16_f32 v77, v58, v59
    v_cvt_pk_bf16_f32 v78, v60, v61
    v_cvt_pk_bf16_f32 v79, v62, v63
    s_waitcnt lgkmcnt(0)
    s_nop 0
    v_mfma_f32_32x32x16_bf16 v[80:95], v[112:115], v[76:79], v[80:95]
    v_smfmac_f32_16x16x64_bf16 v[96:99], v[116:119], v[72:79], v120
    s_setprio 0
    buffer_load_dwordx4 v[100:103], v122, s[44:47], s53 offen
    buffer_load_dwordx4 v[104:107], v122, s[44:47], s53 offen offset:32
    s_nop 4
    v_add_f32 v96, v96, v97
    s_nop 1
    v_max3_f32 v123, abs(v80), abs(v81), abs(v82)
    v_max3_f32 v123, v123, abs(v83), abs(v84)
    v_max3_f32 v123, v123, abs(v85), abs(v86)
    v_max3_f32 v123, v123, abs(v87), abs(v88)
    v_max3_f32 v123, v123, abs(v89), abs(v90)
    v_max3_f32 v123, v123, abs(v91), abs(v92)
    v_max3_f32 v123, v123, abs(v93), abs(v94)
    v_max_f32 v123, v123, abs(v95)
    v_mov_b32 v124, 0x5f800000
    v_cmp_nlt_f32 vcc, v96, v124
    v_mov_b32 v124, 0x7f000000
    v_cmp_nlt_f32 s[100:101], v123, v124
    s_nop 0
    s_or_b64 vcc, vcc, s[100:101]
    s_cbranch_vccnz L_rare_154
L_ret_156:
    v_rcp_f32 v96, v96
    s_nop 0
    v_mul_f32 v80, v80, v96
    v_mul_f32 v81, v81, v96
    v_cvt_pk_bf16_f32 v64, v80, v81
    v_mul_f32 v82, v82, v96
    v_mul_f32 v83, v83, v96
    v_cvt_pk_bf16_f32 v65, v82, v83
    v_mul_f32 v84, v84, v96
    v_mul_f32 v85, v85, v96
    v_cvt_pk_bf16_f32 v66, v84, v85
    v_mul_f32 v86, v86, v96
    v_mul_f32 v87, v87, v96
    v_cvt_pk_bf16_f32 v67, v86, v87
    buffer_store_dwordx4 v[64:67], v2, s[84:87], s26 offen sc1
    v_mul_f32 v88, v88, v96
    v_mul_f32 v89, v89, v96
    v_cvt_pk_bf16_f32 v68, v88, v89
    v_mul_f32 v90, v90, v96
    v_mul_f32 v91, v91, v96
    v_cvt_pk_bf16_f32 v69, v90, v91
    v_mul_f32 v92, v92, v96
    v_mul_f32 v93, v93, v96
    v_cvt_pk_bf16_f32 v70, v92, v93
    v_mul_f32 v94, v94, v96
    v_mul_f32 v95, v95, v96
    v_cvt_pk_bf16_f32 v71, v94, v95
    buffer_store_dwordx4 v[68:71], v2, s[84:87], s26 offen offset:2048 sc1
    v_lshrrev_b32 v126, 3, v1
    v_lshlrev_b32 v126, 14, v126
    v_and_b32 v123, 3, v1
    v_lshl_add_u32 v126, v123, 12, v126
    v_bfe_u32 v123, v1, 2, 1
    v_lshl_add_u32 v126, v123, 10, v126
    s_add_u32 s10, s95, 2100208
    s_and_b32 s12, s26, 0x3fff
    v_add_u32 v123, s12, v2
    s_add_u32 s12, s95, s98
    s_add_u32 s12, s12, 2097152
    v_add_u32 v125, s12, v2
    s_lshl_b32 s13, s5, 14
    s_waitcnt vmcnt(4) lgkmcnt(0)
    s_barrier
    ds_write_b128 v123, v[64:67]
    ds_write_b128 v123, v[68:71] offset:2048
    ds_read_b64_tr_b16 v[240:241], v5 offset:32768
    ds_read_b64_tr_b16 v[242:243], v5 offset:33792
    ds_read_b64_tr_b16 v[244:245], v5 offset:40960
    ds_read_b64_tr_b16 v[246:247], v5 offset:41984
    ds_read_b64_tr_b16 v[248:249], v5 offset:49152
    ds_read_b64_tr_b16 v[250:251], v5 offset:50176
    ds_read_b64_tr_b16 v[252:253], v5 offset:57344
    ds_read_b64_tr_b16 v[254:255], v5 offset:58368
    s_mul_i32 s11, s90, 3072
    v_add_u32 v118, s11, v2
    v_add_u32 v119, 0x10000, v118
    v_xor_b32 v116, 1024, v118
    v_add_u32 v117, 0x10000, v116
    s_lshl_b32 s12, s4, 6
    s_sub_u32 s11, s88, s12
    s_lshl_b32 s12, s90, 5
    s_sub_u32 s11, s11, s12
    v_and_b32 v97, 31, v1
    v_cmp_eq_u32 vcc, s11, v97
    v_lshrrev_b32 v98, 5, v1
    s_lshl_b32 s12, s91, 7
    s_add_u32 s12, s12, 149760
    v_lshl_add_u32 v98, v98, 5, s12
    v_mov_b32 v97, 150272
    v_cndmask_b32 v98, v97, v98, vcc
    ds_read_b128 v[48:51], v98 offset:0
    ds_read_b128 v[52:55], v98 offset:16
    ds_read_b128 v[56:59], v98 offset:64
    ds_read_b128 v[60:63], v98 offset:80
    s_waitcnt vmcnt(2)
    v_lshlrev_b32 v80, 16, v100
    v_and_b32 v81, 0xffff0000, v100
    v_lshlrev_b32 v82, 16, v101
    v_and_b32 v83, 0xffff0000, v101
    v_lshlrev_b32 v84, 16, v102
    v_and_b32 v85, 0xffff0000, v102
    v_lshlrev_b32 v86, 16, v103
    v_and_b32 v87, 0xffff0000, v103
    v_lshlrev_b32 v88, 16, v104
    v_and_b32 v89, 0xffff0000, v104
    v_lshlrev_b32 v90, 16, v105
    v_and_b32 v91, 0xffff0000, v105
    v_lshlrev_b32 v92, 16, v106
    v_and_b32 v93, 0xffff0000, v106
    v_lshlrev_b32 v94, 16, v107
    v_and_b32 v95, 0xffff0000, v107
    v_mul_f32 v120, v3, v4
    v_fma_f32 v8, v80, v4, -v120
    v_fma_f32 v9, v81, v4, -v120
    v_fma_f32 v10, v82, v4, -v120
    v_fma_f32 v11, v83, v4, -v120
    v_fma_f32 v12, v84, v4, -v120
    v_fma_f32 v13, v85, v4, -v120
    v_fma_f32 v14, v86, v4, -v120
    v_fma_f32 v15, v87, v4, -v120
    v_fma_f32 v108, v88, v4, -v120
    v_fma_f32 v109, v89, v4, -v120
    v_fma_f32 v110, v90, v4, -v120
    v_fma_f32 v111, v91, v4, -v120
    v_fma_f32 v112, v92, v4, -v120
    v_fma_f32 v113, v93, v4, -v120
    v_fma_f32 v114, v94, v4, -v120
    v_fma_f32 v115, v95, v4, -v120
    s_waitcnt lgkmcnt(0)
    v_add_f32 v8, v8, v48
    v_add_f32 v9, v9, v49
    v_add_f32 v10, v10, v50
    v_add_f32 v11, v11, v51
    v_add_f32 v12, v12, v52
    v_add_f32 v13, v13, v53
    v_add_f32 v14, v14, v54
    v_add_f32 v15, v15, v55
    v_add_f32 v108, v108, v56
    v_add_f32 v109, v109, v57
    v_add_f32 v110, v110, v58
    v_add_f32 v111, v111, v59
    v_add_f32 v112, v112, v60
    v_add_f32 v113, v113, v61
    v_add_f32 v114, v114, v62
    v_add_f32 v115, v115, v63
    v_mul_f32 v96, 0xbfb8aa3b, v8
    v_mul_f32 v97, 0xbfb8aa3b, v9
    v_mul_f32 v98, 0xbfb8aa3b, v10
    v_mul_f32 v99, 0xbfb8aa3b, v11
    v_mul_f32 v100, 0xbfb8aa3b, v12
    v_mul_f32 v101, 0xbfb8aa3b, v13
    v_mul_f32 v102, 0xbfb8aa3b, v14
    v_mul_f32 v103, 0xbfb8aa3b, v15
    v_exp_f32 v96, v96
    v_exp_f32 v97, v97
    v_exp_f32 v98, v98
    v_exp_f32 v99, v99
    v_exp_f32 v100, v100
    v_exp_f32 v101, v101
    v_exp_f32 v102, v102
    v_exp_f32 v103, v103
    v_add_f32 v96, 1.0, v96
    v_add_f32 v97, 1.0, v97
    v_add_f32 v98, 1.0, v98
    v_add_f32 v99, 1.0, v99
    v_add_f32 v100, 1.0, v100
    v_add_f32 v101, 1.0, v101
    v_add_f32 v102, 1.0, v102
    v_add_f32 v103, 1.0, v103
    v_rcp_f32 v96, v96
    v_rcp_f32 v97, v97
    v_rcp_f32 v98, v98
    v_rcp_f32 v99, v99
    v_rcp_f32 v100, v100
    v_rcp_f32 v101, v101
    v_rcp_f32 v102, v102
    v_rcp_f32 v103, v103
    v_mul_f32 v8, v8, v96
    v_mul_f32 v9, v9, v97
    v_mul_f32 v10, v10, v98
    v_mul_f32 v11, v11, v99
    v_mul_f32 v12, v12, v100
    v_mul_f32 v13, v13, v101
    v_mul_f32 v14, v14, v102
    v_mul_f32 v15, v15, v103
    s_cmp_eq_u32 s3, 0
    s_cbranch_scc0 L_rx_159
    buffer_load_dword v6, v126, s[84:87], s10 offen sc1
L_rx_159:
    v_mul_f32 v96, 0xbfb8aa3b, v108
    v_mul_f32 v97, 0xbfb8aa3b, v109
    v_mul_f32 v98, 0xbfb8aa3b, v110
    v_mul_f32 v99, 0xbfb8aa3b, v111
    v_mul_f32 v100, 0xbfb8aa3b, v112
    v_mul_f32 v101, 0xbfb8aa3b, v113
    v_mul_f32 v102, 0xbfb8aa3b, v114
    v_mul_f32 v103, 0xbfb8aa3b, v115
    v_exp_f32 v96, v96
    v_exp_f32 v97, v97
    v_exp_f32 v98, v98
    v_exp_f32 v99, v99
    v_exp_f32 v100, v100
    v_exp_f32 v101, v101
    v_exp_f32 v102, v102
    v_exp_f32 v103, v103
    v_add_f32 v96, 1.0, v96
    v_add_f32 v97, 1.0, v97
    v_add_f32 v98, 1.0, v98
    v_add_f32 v99, 1.0, v99
    v_add_f32 v100, 1.0, v100
    v_add_f32 v101, 1.0, v101
    v_add_f32 v102, 1.0, v102
    v_add_f32 v103, 1.0, v103
    v_rcp_f32 v96, v96
    v_rcp_f32 v97, v97
    v_rcp_f32 v98, v98
    v_rcp_f32 v99, v99
    v_rcp_f32 v100, v100
    v_rcp_f32 v101, v101
    v_rcp_f32 v102, v102
    v_rcp_f32 v103, v103
    v_mul_f32 v108, v108, v96
    v_mul_f32 v109, v109, v97
    v_mul_f32 v110, v110, v98
    v_mul_f32 v111, v111, v99
    v_mul_f32 v112, v112, v100
    v_mul_f32 v113, v113, v101
    v_mul_f32 v114, v114, v102
    v_mul_f32 v115, v115, v103
    s_cmp_eq_u32 s3, 0
    s_cbranch_scc0 L_rx_162
    buffer_load_dword v7, v126, s[84:87], s10 offen sc1
L_rx_162:
    s_cmp_eq_u32 s3, 0
    s_cbranch_scc0 L_rx_166
    s_mov_b32 s99, 200000
L_poll_164:
    buffer_load_dword v127, v126, s[84:87], s10 offen sc1
    s_waitcnt vmcnt(2)
    v_cmp_eq_u32 vcc, -1, v6
    s_nop 0
    s_cbranch_vccz L_rx_166
    buffer_load_dword v6, v126, s[84:87], s10 offen sc1
    s_waitcnt vmcnt(2)
    v_cmp_eq_u32 vcc, -1, v7
    s_nop 0
    s_cbranch_vccz L_rx_166
    buffer_load_dword v7, v126, s[84:87], s10 offen sc1
    s_waitcnt vmcnt(2)
    v_cmp_eq_u32 vcc, -1, v127
    s_nop 0
    s_cbranch_vccz L_rx_166
    s_sub_u32 s99, s99, 1
    s_cbranch_scc0 L_poll_164
L_rx_166:
    s_waitcnt lgkmcnt(0)
    s_barrier
    s_add_u32 m0, s98, 16384
    s_add_u32 s13, s13, 0x4000
    s_and_b32 s13, s13, 0x1ffff
    buffer_load_dwordx4 v125, s[84:87], s13 offen offset:0 sc1 lds
    buffer_load_dwordx4 v125, s[84:87], s13 offen offset:1024 sc1 lds
    s_add_u32 m0, s98, 32768
    s_add_u32 s13, s13, 0x4000
    s_and_b32 s13, s13, 0x1ffff
    buffer_load_dwordx4 v125, s[84:87], s13 offen offset:0 sc1 lds
    buffer_load_dwordx4 v125, s[84:87], s13 offen offset:1024 sc1 lds
    s_add_u32 m0, s98, 49152
    s_add_u32 s13, s13, 0x4000
    s_and_b32 s13, s13, 0x1ffff
    buffer_load_dwordx4 v125, s[84:87], s13 offen offset:0 sc1 lds
    buffer_load_dwordx4 v125, s[84:87], s13 offen offset:1024 sc1 lds
    ds_read_b128 v[48:51], v116 offset:0
    ds_read_b128 v[52:55], v116 offset:4096
    ds_read_b128 v[56:59], v116 offset:8192
    ds_read_b128 v[60:63], v116 offset:12288
    ds_read_b128 v[64:67], v118 offset:0
    ds_read_b128 v[68:71], v118 offset:4096
    ds_read_b128 v[72:75], v118 offset:8192
    ds_read_b128 v[76:79], v118 offset:12288
    s_waitcnt lgkmcnt(7)
    v_mfma_f32_32x32x16_bf16 v[16:31], v[128:131], v[48:51], 0
    s_waitcnt lgkmcnt(6)
    v_mfma_f32_32x32x16_bf16 v[16:31], v[132:135], v[52:55], v[16:31]
    s_waitcnt lgkmcnt(5)
    v_mfma_f32_32x32x16_bf16 v[16:31], v[136:139], v[56:59], v[16:31]
    s_waitcnt lgkmcnt(4)
    v_mfma_f32_32x32x16_bf16 v[16:31], v[140:143], v[60:63], v[16:31]
    s_waitcnt lgkmcnt(3)
    v_mfma_f32_32x32x16_bf16 v[32:47], v[128:131], v[64:67], 0
    s_waitcnt lgkmcnt(2)
    v_mfma_f32_32x32x16_bf16 v[32:47], v[132:135], v[68:71], v[32:47]
    s_waitcnt lgkmcnt(1)
    v_mfma_f32_32x32x16_bf16 v[32:47], v[136:139], v[72:75], v[32:47]
    s_waitcnt lgkmcnt(0)
    v_mfma_f32_32x32x16_bf16 v[32:47], v[140:143], v[76:79], v[32:47]
    v_mov_b32 v121, 0
    s_lshl_b32 s10, s3, 12
    s_add_u32 s10, s10, 131072
    v_add_u32 v123, s10, v2
    s_xor_b32 s10, s10, 0x4000
    v_add_u32 v124, s10, v2
    v_mov_b32 v104, 0
    s_waitcnt vmcnt(4)
    s_barrier
    ds_read_b128 v[48:51], v116 offset:16384
    ds_read_b128 v[52:55], v116 offset:20480
    ds_read_b128 v[56:59], v116 offset:24576
    ds_read_b128 v[60:63], v116 offset:28672
    ds_read_b128 v[64:67], v118 offset:16384
    ds_read_b128 v[68:71], v118 offset:20480
    ds_read_b128 v[72:75], v118 offset:24576
    ds_read_b128 v[76:79], v118 offset:28672
    s_waitcnt lgkmcnt(7)
    v_mfma_f32_32x32x16_bf16 v[16:31], v[144:147], v[48:51], v[16:31]
    v_max3_u32 v121, v121, v48, v50
    s_waitcnt vmcnt(2)
    s_barrier
    ds_write_b32 v104, v104
    ds_read_b128 v[48:51], v116 offset:32768
    s_waitcnt lgkmcnt(8)
    v_mfma_f32_32x32x16_bf16 v[16:31], v[148:151], v[52:55], v[16:31]
    v_max3_u32 v121, v121, v52, v54
    ds_read_b128 v[52:55], v116 offset:36864
    s_add_u32 m0, s98, 65536
    s_add_u32 s13, s13, 0x4000
    s_and_b32 s13, s13, 0x1ffff
    buffer_load_dwordx4 v125, s[84:87], s13 offen offset:0 sc1 lds
    buffer_load_dwordx4 v125, s[84:87], s13 offen offset:1024 sc1 lds
    s_waitcnt lgkmcnt(8)
    v_mfma_f32_32x32x16_bf16 v[16:31], v[152:155], v[56:59], v[16:31]
    v_max3_u32 v121, v121, v56, v58
    ds_read_b128 v[56:59], v116 offset:40960
    s_waitcnt lgkmcnt(8)
    v_mfma_f32_32x32x16_bf16 v[16:31], v[156:159], v[60:63], v[16:31]
    v_max3_u32 v121, v121, v60, v62
    ds_read_b128 v[60:63], v116 offset:45056
    s_waitcnt lgkmcnt(8)
    v_mfma_f32_32x32x16_bf16 v[32:47], v[144:147], v[64:67], v[32:47]
    v_max3_u32 v121, v121, v64, v66
    ds_read_b128 v[64:67], v118 offset:32768
    s_waitcnt lgkmcnt(8)
    v_mfma_f32_32x32x16_bf16 v[32:47], v[148:151], v[68:71], v[32:47]
    v_max3_u32 v121, v121, v68, v70
    ds_read_b128 v[68:71], v118 offset:36864
    s_add_u32 m0, s98, 81920
    s_add_u32 s13, s13, 0x4000
    s_and_b32 s13, s13, 0x1ffff
    buffer_load_dwordx4 v125, s[84:87], s13 offen offset:0 sc1 lds
    buffer_load_dwordx4 v125, s[84:87], s13 offen offset:1024 sc1 lds
    s_waitcnt lgkmcnt(8)
    v_mfma_f32_32x32x16_bf16 v[32:47], v[152:155], v[72:75], v[32:47]
    v_max3_u32 v121, v121, v72, v74
    ds_read_b128 v[72:75], v118 offset:40960
    s_waitcnt lgkmcnt(8)
    v_mfma_f32_32x32x16_bf16 v[32:47], v[156:159], v[76:79], v[32:47]
    v_max3_u32 v121, v121, v76, v78
    ds_read_b128 v[76:79], v118 offset:45056
    s_waitcnt lgkmcnt(7)
    v_mfma_f32_32x32x16_bf16 v[16:31], v[160:163], v[48:51], v[16:31]
    v_max3_u32 v121, v121, v48, v50
    s_waitcnt vmcnt(4)
    s_barrier
    ds_read_b128 v[48:51], v116 offset:49152
    s_waitcnt lgkmcnt(7)
    v_mfma_f32_32x32x16_bf16 v[16:31], v[164:167], v[52:55], v[16:31]
    v_max3_u32 v121, v121, v52, v54
    ds_read_b128 v[52:55], v116 offset:53248
    s_add_u32 m0, s98, 98304
    s_add_u32 s13, s13, 0x4000
    s_and_b32 s13, s13, 0x1ffff
    buffer_load_dwordx4 v125, s[84:87], s13 offen offset:0 sc1 lds
    buffer_load_dwordx4 v125, s[84:87], s13 offen offset:1024 sc1 lds
    s_waitcnt lgkmcnt(7)
    v_mfma_f32_32x32x16_bf16 v[16:31], v[168:171], v[56:59], v[16:31]
    v_max3_u32 v121, v121, v56, v58
    ds_read_b128 v[56:59], v116 offset:57344
    s_waitcnt lgkmcnt(7)
    v_mfma_f32_32x32x16_bf16 v[16:31], v[172:175], v[60:63], v[16:31]
    v_max3_u32 v121, v121, v60, v62
    ds_read_b128 v[60:63], v116 offset:61440
    s_waitcnt lgkmcnt(7)
    v_mfma_f32_32x32x16_bf16 v[32:47], v[160:163], v[64:67], v[32:47]
    v_max3_u32 v121, v121, v64, v66
    ds_read_b128 v[64:67], v118 offset:49152
    s_waitcnt lgkmcnt(7)
    v_mfma_f32_32x32x16_bf16 v[32:47], v[164:167], v[68:71], v[32:47]
    v_max3_u32 v121, v121, v68, v70
    ds_read_b128 v[68:71], v118 offset:53248
    s_add_u32 m0, s98, 114688
    s_add_u32 s13, s13, 0x4000
    s_and_b32 s13, s13, 0x1ffff
    buffer_load_dwordx4 v125, s[84:87], s13 offen offset:0 sc1 lds
    buffer_load_dwordx4 v125, s[84:87], s13 offen offset:1024 sc1 lds
    s_waitcnt lgkmcnt(7)
    v_mfma_f32_32x32x16_bf16 v[32:47], v[168:171], v[72:75], v[32:47]
    v_max3_u32 v121, v121, v72, v74
    ds_read_b128 v[72:75], v118 offset:57344
    s_waitcnt lgkmcnt(7)
    v_mfma_f32_32x32x16_bf16 v[32:47], v[172:175], v[76:79], v[32:47]
    v_max3_u32 v121, v121, v76, v78
    ds_read_b128 v[76:79], v118 offset:61440
    s_waitcnt lgkmcnt(7)
    v_mfma_f32_32x32x16_bf16 v[16:31], v[176:179], v[48:51], v[16:31]
    v_max3_u32 v121, v121, v48, v50
    s_waitcnt vmcnt(6)
    s_barrier
    ds_read_b128 v[48:51], v117 offset:0
    s_waitcnt lgkmcnt(7)
    v_mfma_f32_32x32x16_bf16 v[16:31], v[180:183], v[52:55], v[16:31]
    v_max3_u32 v121, v121, v52, v54
    ds_read_b128 v[52:55], v117 offset:4096
    s_waitcnt lgkmcnt(7)
    v_mfma_f32_32x32x16_bf16 v[16:31], v[184:187], v[56:59], v[16:31]
    v_max3_u32 v121, v121, v56, v58
    ds_read_b128 v[56:59], v117 offset:8192
    s_waitcnt lgkmcnt(7)
    v_mfma_f32_32x32x16_bf16 v[16:31], v[188:191], v[60:63], v[16:31]
    v_max3_u32 v121, v121, v60, v62
    ds_read_b128 v[60:63], v117 offset:12288
    s_waitcnt lgkmcnt(7)
    v_mfma_f32_32x32x16_bf16 v[32:47], v[176:179], v[64:67], v[32:47]
    v_max3_u32 v121, v121, v64, v66
    ds_read_b128 v[64:67], v119 offset:0
    s_waitcnt lgkmcnt(7)
    v_mfma_f32_32x32x16_bf16 v[32:47], v[180:183], v[68:71], v[32:47]
    v_max3_u32 v121, v121, v68, v70
    ds_read_b128 v[68:71], v119 offset:4096
    s_waitcnt lgkmcnt(7)
    v_mfma_f32_32x32x16_bf16 v[32:47], v[184:187], v[72:75], v[32:47]
    v_max3_u32 v121, v121, v72, v74
    ds_read_b128 v[72:75], v119 offset:8192
    s_waitcnt lgkmcnt(7)
    v_mfma_f32_32x32x16_bf16 v[32:47], v[188:191], v[76:79], v[32:47]
    v_max3_u32 v121, v121, v76, v78
    ds_read_b128 v[76:79], v119 offset:12288
    s_waitcnt lgkmcnt(7)
    v_mfma_f32_32x32x16_bf16 v[16:31], v[192:195], v[48:51], v[16:31]
    v_max3_u32 v121, v121, v48, v50
    s_waitcnt vmcnt(4)
    s_barrier
    ds_read_b128 v[48:51], v117 offset:16384
    s_waitcnt lgkmcnt(7)
    v_mfma_f32_32x32x16_bf16 v[16:31], v[196:199], v[52:55], v[16:31]
    v_max3_u32 v121, v121, v52, v54
    ds_read_b128 v[52:55], v117 offset:20480
    s_waitcnt lgkmcnt(7)
    v_mfma_f32_32x32x16_bf16 v[16:31], v[200:203], v[56:59], v[16:31]
    v_max3_u32 v121, v121, v56, v58
    ds_read_b128 v[56:59], v117 offset:24576
    s_waitcnt lgkmcnt(7)
    v_mfma_f32_32x32x16_bf16 v[16:31], v[204:207], v[60:63], v[16:31]
    v_max3_u32 v121, v121, v60, v62
    ds_read_b128 v[60:63], v117 offset:28672
    s_waitcnt lgkmcnt(7)
    v_mfma_f32_32x32x16_bf16 v[32:47], v[192:195], v[64:67], v[32:47]
    v_max3_u32 v121, v121, v64, v66
    ds_read_b128 v[64:67], v119 offset:16384
    s_waitcnt lgkmcnt(7)
    v_mfma_f32_32x32x16_bf16 v[32:47], v[196:199], v[68:71], v[32:47]
    v_max3_u32 v121, v121, v68, v70
    ds_read_b128 v[68:71], v119 offset:20480
    s_waitcnt lgkmcnt(7)
    v_mfma_f32_32x32x16_bf16 v[32:47], v[200:203], v[72:75], v[32:47]
    v_max3_u32 v121, v121, v72, v74
    ds_read_b128 v[72:75], v119 offset:24576
    s_waitcnt lgkmcnt(7)
    v_mfma_f32_32x32x16_bf16 v[32:47], v[204:207], v[76:79], v[32:47]
    v_max3_u32 v121, v121, v76, v78
    ds_read_b128 v[76:79], v119 offset:28672
    s_waitcnt lgkmcnt(7)
    v_mfma_f32_32x32x16_bf16 v[16:31], v[208:211], v[48:51], v[16:31]
    v_max3_u32 v121, v121, v48, v50
    s_waitcnt vmcnt(2)
    s_barrier
    ds_read_b128 v[48:51], v117 offset:32768
    s_waitcnt lgkmcnt(7)
    v_mfma_f32_32x32x16_bf16 v[16:31], v[212:215], v[52:55], v[16:31]
    v_max3_u32 v121, v121, v52, v54
    ds_read_b128 v[52:55], v117 offset:36864
    s_waitcnt lgkmcnt(7)
    v_mfma_f32_32x32x16_bf16 v[16:31], v[216:219], v[56:59], v[16:31]
    v_max3_u32 v121, v121, v56, v58
    ds_read_b128 v[56:59], v117 offset:40960
    s_waitcnt lgkmcnt(7)
    v_mfma_f32_32x32x16_bf16 v[16:31], v[220:223], v[60:63], v[16:31]
    v_max3_u32 v121, v121, v60, v62
    ds_read_b128 v[60:63], v117 offset:45056
    s_waitcnt lgkmcnt(7)
    v_mfma_f32_32x32x16_bf16 v[32:47], v[208:211], v[64:67], v[32:47]
    v_max3_u32 v121, v121, v64, v66
    s_waitcnt vmcnt(0)
    s_barrier
    ds_read_b128 v[64:67], v117 offset:49152
    s_waitcnt lgkmcnt(7)
    v_mfma_f32_32x32x16_bf16 v[32:47], v[212:215], v[68:71], v[32:47]
    v_max3_u32 v121, v121, v68, v70
    ds_read_b128 v[68:71], v117 offset:53248
    s_waitcnt lgkmcnt(7)
    v_mfma_f32_32x32x16_bf16 v[32:47], v[216:219], v[72:75], v[32:47]
    v_max3_u32 v121, v121, v72, v74
    ds_read_b128 v[72:75], v117 offset:57344
    s_waitcnt lgkmcnt(7)
    v_mfma_f32_32x32x16_bf16 v[32:47], v[220:223], v[76:79], v[32:47]
    v_max3_u32 v121, v121, v76, v78
    ds_read_b128 v[76:79], v117 offset:61440
    s_waitcnt lgkmcnt(7)
    v_mfma_f32_32x32x16_bf16 v[16:31], v[224:227], v[48:51], v[16:31]
    v_max3_u32 v121, v121, v48, v50
    ds_read_b128 v[48:51], v119 offset:32768
    s_waitcnt lgkmcnt(7)
    v_mfma_f32_32x32x16_bf16 v[16:31], v[228:231], v[52:55], v[16:31]
    v_max3_u32 v121, v121, v52, v54
    ds_read_b128 v[52:55], v119 offset:36864
    s_waitcnt lgkmcnt(7)
    v_mfma_f32_32x32x16_bf16 v[16:31], v[232:235], v[56:59], v[16:31]
    v_max3_u32 v121, v121, v56, v58
    ds_read_b128 v[56:59], v119 offset:40960
    s_waitcnt lgkmcnt(7)
    v_mfma_f32_32x32x16_bf16 v[16:31], v[236:239], v[60:63], v[16:31]
    v_max3_u32 v121, v121, v60, v62
    ds_read_b128 v[60:63], v119 offset:45056
    s_waitcnt lgkmcnt(7)
    v_mfma_f32_32x32x16_bf16 v[16:31], v[240:243], v[64:67], v[16:31]
    v_max3_u32 v121, v121, v64, v66
    ds_read_b128 v[64:67], v119 offset:49152
    s_waitcnt lgkmcnt(7)
    v_mfma_f32_32x32x16_bf16 v[16:31], v[244:247], v[68:71], v[16:31]
    v_max3_u32 v121, v121, v68, v70
    ds_read_b128 v[68:71], v119 offset:53248
    s_waitcnt lgkmcnt(7)
    v_mfma_f32_32x32x16_bf16 v[16:31], v[248:251], v[72:75], v[16:31]
    v_max3_u32 v121, v121, v72, v74
    ds_read_b128 v[72:75], v119 offset:57344
    s_waitcnt lgkmcnt(7)
    v_mfma_f32_32x32x16_bf16 v[16:31], v[252:255], v[76:79], v[16:31]
    v_max3_u32 v121, v121, v76, v78
    ds_read_b128 v[76:79], v119 offset:61440
    s_waitcnt lgkmcnt(7)
    v_mfma_f32_32x32x16_bf16 v[32:47], v[224:227], v[48:51], v[32:47]
    v_max3_u32 v121, v121, v48, v50
    s_waitcnt lgkmcnt(6)
    v_mfma_f32_32x32x16_bf16 v[32:47], v[228:231], v[52:55], v[32:47]
    v_max3_u32 v121, v121, v52, v54
    s_nop 3
    ds_write_b128 v123, v[16:19] offset:0
    s_waitcnt lgkmcnt(6)
    v_mfma_f32_32x32x16_bf16 v[32:47], v[232:235], v[56:59], v[32:47]
    v_max3_u32 v121, v121, v56, v58
    ds_write_b128 v123, v[20:23] offset:1024
    s_waitcnt lgkmcnt(6)
    v_mfma_f32_32x32x16_bf16 v[32:47], v[236:239], v[60:63], v[32:47]
    v_max3_u32 v121, v121, v60, v62
    ds_write_b128 v123, v[24:27] offset:2048
    ds_write_b128 v123, v[28:31] offset:3072
    s_waitcnt lgkmcnt(7)
    v_mfma_f32_32x32x16_bf16 v[32:47], v[240:243], v[64:67], v[32:47]
    v_max3_u32 v121, v121, v64, v66
    s_waitcnt lgkmcnt(6)
    v_mfma_f32_32x32x16_bf16 v[32:47], v[244:247], v[68:71], v[32:47]
    v_max3_u32 v121, v121, v68, v70
    s_waitcnt lgkmcnt(0)
    v_max3_u32 v121, v121, v72, v74
    v_max3_u32 v121, v121, v76, v78
    v_cmp_eq_u32 vcc, -1, v121
    s_nop 0
    s_cbranch_vccnz L_rare_168
L_ret_170:
    s_barrier
    ds_read_b32 v105, v104
    ds_read_b128 v[16:19], v124 offset:0
    ds_read_b128 v[20:23], v124 offset:1024
    ds_read_b128 v[24:27], v124 offset:2048
    ds_read_b128 v[28:31], v124 offset:3072
    v_mfma_f32_32x32x16_bf16 v[32:47], v[248:251], v[72:75], v[32:47]
    v_mfma_f32_32x32x16_bf16 v[32:47], v[252:255], v[76:79], v[32:47]
    s_waitcnt lgkmcnt(4)
    v_cmp_ne_u32 vcc, 0, v105
    s_nop 0
    s_cbranch_vccnz L_rare_171
L_ret_173:
    s_waitcnt lgkmcnt(0)
    v_fma_f32 v16, v16, v8, v80
    v_fma_f32 v17, v17, v9, v81
    v_fma_f32 v18, v18, v10, v82
    v_fma_f32 v19, v19, v11, v83
    v_fma_f32 v20, v20, v12, v84
    v_fma_f32 v21, v21, v13, v85
    v_fma_f32 v22, v22, v14, v86
    v_fma_f32 v23, v23, v15, v87
    v_fma_f32 v24, v24, v108, v88
    v_fma_f32 v25, v25, v109, v89
    v_fma_f32 v26, v26, v110, v90
    v_fma_f32 v27, v27, v111, v91
    v_fma_f32 v28, v28, v112, v92
    v_fma_f32 v29, v29, v113, v93
    v_fma_f32 v30, v30, v114, v94
    v_fma_f32 v31, v31, v115, v95
    v_fma_f32 v32, v32, v8, v16
    v_fma_f32 v33, v33, v9, v17
    v_fma_f32 v34, v34, v10, v18
    v_fma_f32 v35, v35, v11, v19
    v_cvt_pk_bf16_f32 v64, v32, v33
    v_cvt_pk_bf16_f32 v65, v34, v35
    v_fma_f32 v36, v36, v12, v20
    v_fma_f32 v37, v37, v13, v21
    v_fma_f32 v38, v38, v14, v22
    v_fma_f32 v39, v39, v15, v23
    v_cvt_pk_bf16_f32 v66, v36, v37
    v_cvt_pk_bf16_f32 v67, v38, v39
    buffer_store_dwordx4 v[64:67], v122, s[76:79], s53 offen offset:0
    v_fma_f32 v40, v40, v108, v24
    v_fma_f32 v41, v41, v109, v25
    v_fma_f32 v42, v42, v110, v26
    v_fma_f32 v43, v43, v111, v27
    v_cvt_pk_bf16_f32 v68, v40, v41
    v_cvt_pk_bf16_f32 v69, v42, v43
    v_fma_f32 v44, v44, v112, v28
    v_fma_f32 v45, v45, v113, v29
    v_fma_f32 v46, v46, v114, v30
    v_fma_f32 v47, v47, v115, v31
    v_cvt_pk_bf16_f32 v70, v44, v45
    v_cvt_pk_bf16_f32 v71, v46, v47
    buffer_store_dwordx4 v[68:71], v122, s[76:79], s53 offen offset:32
L_end:
    s_endpgm
L_rare_1:
    s_and_b32 s10, s9, 15
    s_lshl_b32 s10, s10, 12
    buffer_load_dword v13, v10, s[52:55], s10 offen
L_rx_2:
    s_nop 4
    s_branch L_ret_3
L_rare_4:
    v_mov_b32 v232, 0
    v_mov_b32 v233, 0
    v_mov_b32 v234, 0
    v_mov_b32 v235, 0
    s_lshl_b32 s10, s4, 8
    s_lshl_b32 s11, s5, 5
    s_add_u32 s10, s10, s11
    s_add_u32 s10, s10, 1572864
    s_lshl_b32 s11, s7, 7
    s_lshl2_add_u32 s11, s9, s11
    s_add_u32 s11, s11, 270336
    s_lshl_b32 s12, s7, 13
    s_lshl_b32 s13, s9, 8
    s_add_u32 s12, s12, s13
    s_add_u32 s12, s12, 589824
    v_add_u32 v14, s10, v11
    v_writelane_b32 v14, s11, 8
    buffer_store_dword v232, v11, s[84:87], s12 offen sc1
    s_mul_i32 s10, s7, 28
    s_add_u32 s10, s10, s9
    s_cmp_lt_u32 s9, 28
    s_cselect_b32 s10, s10, s2
    s_lshl_b32 s10, s10, 10
    s_add_u32 s10, s10, 278528
    buffer_store_dwordx4 v[232:235], v2, s[84:87], s10 offen sc1
    s_mov_b64 exec, 0x1ff
    buffer_store_dword v232, v14, s[84:87], 0 offen sc1
    s_mov_b64 exec, -1
L_rx_5:
    s_nop 4
    s_branch L_ret_6
L_wd_8:
    s_waitcnt vmcnt(6) lgkmcnt(0)
    s_branch L_we_7
L_wd_9:
    s_waitcnt vmcnt(4) lgkmcnt(0)
    s_branch L_we_7
L_rare_12:
    s_waitcnt vmcnt(4)
    s_and_b32 s10, s2, 15
    s_lshl_b32 s10, s10, 4
    v_mov_b32 v14, 1
    v_mov_b32 v15, 0
    s_mov_b64 exec, 1
    buffer_atomic_add v14, v15, s[80:83], s10 offen sc1
    s_mov_b64 exec, -1
L_rx_13:
    s_nop 4
    s_branch L_ret_14
L_wd_16:
    s_waitcnt vmcnt(9) lgkmcnt(0)
    s_branch L_we_15
L_wd_17:
    s_waitcnt vmcnt(6) lgkmcnt(0)
    s_branch L_we_15
L_wd_19:
    s_waitcnt vmcnt(5) lgkmcnt(0)
    s_branch L_we_18
L_rare_21:
    v_mov_b32 v220, 0
    v_mov_b32 v221, 0
    v_mov_b32 v222, 0
    v_mov_b32 v223, 0
    s_nop 1
    v_smfmac_f32_16x16x64_bf16 v[220:223], v[116:119], v[128:135], v120
    v_smfmac_f32_16x16x64_bf16 v[220:223], v[116:119], v[136:143], v120
    v_smfmac_f32_16x16x64_bf16 v[220:223], v[116:119], v[144:151], v120
    v_smfmac_f32_16x16x64_bf16 v[220:223], v[116:119], v[152:159], v120
    v_smfmac_f32_16x16x64_bf16 v[220:223], v[116:119], v[160:167], v120
    v_smfmac_f32_16x16x64_bf16 v[220:223], v[116:119], v[168:175], v120
    v_smfmac_f32_16x16x64_bf16 v[220:223], v[116:119], v[176:183], v120
    v_smfmac_f32_16x16x64_bf16 v[220:223], v[116:119], v[184:191], v120
    s_lshl_b32 s10, s90, 6
    s_add_u32 s10, s10, 159744
    v_lshl_add_u32 v14, v7, 2, s10
    s_nop 4
    v_add_f32 v220, v220, v221
    v_mov_b32 v221, v220
    s_nop 1
    v_permlane16_swap_b32 v220, v221
    v_add_f32 v220, v220, v221
    s_mov_b64 exec, 0xffff
    ds_write_b32 v14, v220
    s_mov_b64 exec, -1
L_rx_22:
    s_nop 4
    s_branch L_ret_23
L_rare_26:
    v_mov_b32 v14, 159744
    ds_read_b128 v[128:131], v14 offset:0
    ds_read_b128 v[132:135], v14 offset:16
    ds_read_b32 v220, v14 offset:32
    ds_read_b128 v[136:139], v14 offset:64
    ds_read_b128 v[140:143], v14 offset:80
    ds_read_b32 v221, v14 offset:96
L_rx_27:
    s_nop 4
    s_branch L_ret_28
L_rare_33:
    v_add_f32 v128, v128, v136
    v_add_f32 v129, v129, v137
    v_add_f32 v130, v130, v138
    v_add_f32 v131, v131, v139
    v_add_f32 v132, v132, v140
    v_add_f32 v133, v133, v141
    v_add_f32 v134, v134, v142
    v_add_f32 v135, v135, v143
    v_add_f32 v220, v220, v221
L_rx_34:
    s_nop 4
    s_branch L_ret_35
L_rare_37:
    buffer_load_dword v208, v209, s[80:83], 0 offen sc1
L_rx_38:
    s_nop 4
    s_branch L_ret_39
L_wd_41:
    s_waitcnt vmcnt(3) lgkmcnt(0)
    s_branch L_we_40
L_rare_43:
    s_setprio 3
    ds_read_b128 v[152:155], v14 offset:32768
    v_xor_b32 v192, 16, v14
    ds_read_b128 v[156:159], v192 offset:32768
    v_xor_b32 v193, 64, v14
    ds_read_b128 v[160:163], v193 offset:32768
    v_xor_b32 v194, 80, v14
    ds_read_b128 v[164:167], v194 offset:32768
L_rx_44:
    s_nop 4
    s_branch L_ret_45
L_rare_48:
    v_add_f32 v152, v152, v160
    v_add_f32 v153, v153, v161
    v_add_f32 v154, v154, v162
    v_add_f32 v155, v155, v163
    v_add_f32 v156, v156, v164
    v_add_f32 v157, v157, v165
    v_add_f32 v158, v158, v166
    v_add_f32 v159, v159, v167
    v_fma_f32 v152, -v17, v128, v152
    v_mul_f32 v152, v152, v18
    v_fma_f32 v153, -v17, v129, v153
    v_mul_f32 v153, v153, v18
    v_cvt_pk_bf16_f32 v160, v152, v153
    v_fma_f32 v154, -v17, v130, v154
    v_mul_f32 v154, v154, v18
    v_fma_f32 v155, -v17, v131, v155
    v_mul_f32 v155, v155, v18
    v_cvt_pk_bf16_f32 v161, v154, v155
    v_fma_f32 v156, -v17, v132, v156
    v_mul_f32 v156, v156, v18
    v_fma_f32 v157, -v17, v133, v157
    v_mul_f32 v157, v157, v18
    v_cvt_pk_bf16_f32 v162, v156, v157
    v_fma_f32 v158, -v17, v134, v158
    v_mul_f32 v158, v158, v18
    v_fma_f32 v159, -v17, v135, v159
    v_mul_f32 v159, v159, v18
    v_cvt_pk_bf16_f32 v163, v158, v159
    s_cmp_lt_u32 s5, 4
    s_cbranch_scc1 L_st_47
    ds_write_b16 v237, v160 offset:32896
    ds_write_b16_d16_hi v237, v160 offset:33152
    ds_write_b16 v237, v161 offset:33408
    ds_write_b16_d16_hi v237, v161 offset:33664
    ds_write_b16 v237, v162 offset:33920
    ds_write_b16_d16_hi v237, v162 offset:34176
    ds_write_b16 v237, v163 offset:34432
    ds_write_b16_d16_hi v237, v163 offset:34688
    ds_read_b128 v[160:163], v238 offset:32896
    s_waitcnt lgkmcnt(0)
L_st_47:
    buffer_store_dwordx4 v[160:163], v236, s[84:87], 0 offen sc1
    s_cmp_lg_u32 s5, 0
    s_cbranch_scc1 L_rx_49
    v_add_f32 v19, v144, v146
    v_fma_f32 v19, -v17, v220, v19
    v_mul_f32 v19, v19, v18
    v_cvt_pk_bf16_f32 v153, v19, v19
    v_and_b32 v153, 0xffff0000, v153
    v_ashrrev_i32 v21, 31, v153
    v_or_b32 v21, 0x80000000, v21
    v_xor_b32 v21, v21, v153
    v_and_b32 v21, 0xffff0000, v21
    s_lshl_b32 s10, s4, 6
    s_sub_u32 s10, 2047, s10
    v_sub_u32 v152, s10, v1
    v_or_b32 v152, v152, v21
    v_mov_b32 v21, v152
    v_mov_b32 v154, v17
    v_mov_b32 v155, v18
    v_max_u32_dpp v21, v21, v21 row_shr:1 row_mask:0xf bank_mask:0xf
    s_nop 1
    v_max_u32_dpp v21, v21, v21 row_shr:2 row_mask:0xf bank_mask:0xf
    s_nop 1
    v_max_u32_dpp v21, v21, v21 row_shr:4 row_mask:0xf bank_mask:0xf
    s_nop 1
    v_max_u32_dpp v21, v21, v21 row_shr:8 row_mask:0xf bank_mask:0xf
    s_nop 1
    v_max_u32_dpp v21, v21, v21 row_bcast:15 row_mask:0xa bank_mask:0xf
    s_nop 1
    v_max_u32_dpp v21, v21, v21 row_bcast:31 row_mask:0xc bank_mask:0xf
    s_nop 0
    v_readlane_b32 s12, v21, 63
    s_lshl_b32 s10, s4, 4
    s_add_u32 s10, s10, 262144
    v_mov_b32 v21, 0
    v_cmp_eq_u32 vcc, s12, v152
    s_nop 0
    s_mov_b64 exec, vcc
    buffer_store_dwordx4 v[152:155], v21, s[84:87], s10 offen sc1
    s_mov_b64 exec, -1
L_rx_49:
    s_nop 4
    s_branch L_ret_50
L_wd_52:
    s_waitcnt vmcnt(4) lgkmcnt(0)
    s_branch L_we_51
L_rare_54:
    s_waitcnt vmcnt(5)
    v_mov_b32 v14, 1
    v_mov_b32 v15, 270336
    s_mov_b64 exec, 1
    buffer_store_dword v14, v15, s[84:87], s54 offen sc1
    s_mov_b64 exec, -1
L_rx_55:
    s_nop 4
    s_branch L_ret_56
L_wd_58:
    s_waitcnt vmcnt(5) lgkmcnt(0)
    s_branch L_we_57
L_wd_60:
    s_waitcnt vmcnt(7) lgkmcnt(0)
    s_branch L_we_59
L_wd_62:
    s_waitcnt vmcnt(7) lgkmcnt(0)
    s_branch L_we_61
L_rare_65:
    s_waitcnt vmcnt(14)
    s_mov_b32 s100, 0x11111111
    s_mov_b32 s101, 0x11111111
    v_cmp_le_u32 vcc, 16, v208
    s_nop 0
    s_and_b64 vcc, vcc, s[100:101]
    s_cmp_eq_u64 vcc, s[100:101]
    s_cbranch_scc1 L_ok_68
    s_mov_b32 s99, 200000
    s_mov_b32 s100, 0x11111111
    s_mov_b32 s101, 0x11111111
L_poll_69:
    buffer_load_dword v208, v209, s[80:83], 0 offen sc1
    s_waitcnt vmcnt(0)
    v_cmp_le_u32 vcc, 16, v208
    s_nop 0
    s_and_b64 vcc, vcc, s[100:101]
    s_sub_u32 s99, s99, 1
    s_cbranch_scc1 L_ok_68
    s_cmp_lg_u64 vcc, s[100:101]
    s_cbranch_scc1 L_poll_69
L_ok_68:
    s_and_b32 s10, s54, 0x380
    s_add_u32 s10, s10, 270336
    buffer_load_dword v210, v211, s[84:87], s10 offen sc1
L_rx_66:
    s_nop 4
    s_branch L_ret_67
L_wd_71:
    s_waitcnt vmcnt(3) lgkmcnt(0)
    s_branch L_we_70
L_rare_73:
    s_waitcnt vmcnt(0)
    v_cmp_ne_u32 vcc, 1, v210
    s_nop 0
    s_cbranch_vccz L_rx_74
    s_and_b32 s10, s54, 0x380
    s_add_u32 s10, s10, 270336
    s_mov_b32 s99, 200000
L_poll_76:
    buffer_load_dword v210, v211, s[84:87], s10 offen sc1
    s_waitcnt vmcnt(0)
    v_cmp_ne_u32 vcc, 1, v210
    s_sub_u32 s99, s99, 1
    s_cbranch_scc1 L_rx_74
    s_cbranch_vccnz L_poll_76
L_rx_74:
    s_nop 4
    s_branch L_ret_75
L_wd_78:
    s_waitcnt vmcnt(1) lgkmcnt(0)
    s_branch L_we_77
L_rare_114:
    s_mov_b32 s99, 200000
L_poll_117:
    buffer_load_dwordx4 v[224:227], v2, s[84:87], s24 offen offset:0 sc1
    buffer_load_dwordx4 v[228:231], v2, s[84:87], s24 offen offset:1024 sc1
    buffer_load_dwordx4 v[232:235], v2, s[84:87], s24 offen offset:2048 sc1
    buffer_load_dwordx4 v[236:239], v2, s[84:87], s24 offen offset:3072 sc1
    s_waitcnt vmcnt(0)
    v_and_b32 v123, v225, v227
    v_and_b32 v124, v229, v231
    v_and_b32 v123, v123, v124
    v_and_b32 v124, v233, v235
    v_and_b32 v123, v123, v124
    v_and_b32 v124, v237, v239
    v_and_b32 v123, v123, v124
    v_cmp_ne_u32 vcc, 1, v123
    s_sub_u32 s99, s99, 1
    s_cbranch_scc1 L_rx_115
    s_cbranch_vccnz L_poll_117
L_rx_115:
    s_nop 4
    s_branch L_ret_116
L_wd_145:
    s_waitcnt vmcnt(7)
    s_branch L_we_144
L_wd_146:
    s_waitcnt vmcnt(7)
    s_branch L_we_144
L_rare_154:
    v_mov_b32 v123, 0xff800000
    s_mov_b32 s10, 0
L_slow1:
    buffer_load_dwordx4 v[32:35], v2, s[84:87], s10 offen sc1
    buffer_load_dwordx4 v[36:39], v2, s[84:87], s10 offen offset:1024 sc1
    s_waitcnt vmcnt(0)
    v_mfma_f32_32x32x16_bf16 v[48:63], v[32:35], v[8:11], 0
    v_mfma_f32_32x32x16_bf16 v[48:63], v[36:39], v[12:15], v[48:63]
    s_nop 11
    v_max3_f32 v123, v123, v48, v49
    v_max3_f32 v123, v123, v50, v51
    v_max3_f32 v123, v123, v52, v53
    v_max3_f32 v123, v123, v54, v55
    v_max3_f32 v123, v123, v56, v57
    v_max3_f32 v123, v123, v58, v59
    v_max3_f32 v123, v123, v60, v61
    v_max3_f32 v123, v123, v62, v63
    s_add_u32 s10, s10, 4096
    s_cmp_lt_u32 s10, 262144
    s_cbranch_scc1 L_slow1
    v_mov_b32 v124, v123
    s_nop 1
    v_permlane32_swap_b32 v123, v124
    v_max_f32 v123, v123, v124
    v_sub_f32 v16, 0, v123
    v_mov_b32 v80, 0
    v_sub_f32 v17, 0, v123
    v_mov_b32 v81, 0
    v_sub_f32 v18, 0, v123
    v_mov_b32 v82, 0
    v_sub_f32 v19, 0, v123
    v_mov_b32 v83, 0
    v_sub_f32 v20, 0, v123
    v_mov_b32 v84, 0
    v_sub_f32 v21, 0, v123
    v_mov_b32 v85, 0
    v_sub_f32 v22, 0, v123
    v_mov_b32 v86, 0
    v_sub_f32 v23, 0, v123
    v_mov_b32 v87, 0
    v_sub_f32 v24, 0, v123
    v_mov_b32 v88, 0
    v_sub_f32 v25, 0, v123
    v_mov_b32 v89, 0
    v_sub_f32 v26, 0, v123
    v_mov_b32 v90, 0
    v_sub_f32 v27, 0, v123
    v_mov_b32 v91, 0
    v_sub_f32 v28, 0, v123
    v_mov_b32 v92, 0
    v_sub_f32 v29, 0, v123
    v_mov_b32 v93, 0
    v_sub_f32 v30, 0, v123
    v_mov_b32 v94, 0
    v_sub_f32 v31, 0, v123
    v_mov_b32 v95, 0
    v_mov_b32 v96, 0
    v_mov_b32 v97, 0
    v_mov_b32 v98, 0
    v_mov_b32 v99, 0
    s_mov_b32 s10, 0
L_slow2:
    buffer_load_dwordx4 v[32:35], v2, s[84:87], s10 offen offset:0 sc1
    buffer_load_dwordx4 v[36:39], v2, s[84:87], s10 offen offset:1024 sc1
    buffer_load_dwordx4 v[40:43], v2, s[84:87], s10 offen offset:2048 sc1
    buffer_load_dwordx4 v[44:47], v2, s[84:87], s10 offen offset:3072 sc1
    s_waitcnt vmcnt(0)
    v_mfma_f32_32x32x16_bf16 v[48:63], v[32:35], v[8:11], v[16:31]
    v_mfma_f32_32x32x16_bf16 v[48:63], v[36:39], v[12:15], v[48:63]
    s_nop 11
    v_exp_f32 v48, v48
    v_exp_f32 v49, v49
    v_exp_f32 v50, v50
    v_exp_f32 v51, v51
    v_exp_f32 v52, v52
    v_exp_f32 v53, v53
    v_exp_f32 v54, v54
    v_exp_f32 v55, v55
    v_exp_f32 v56, v56
    v_exp_f32 v57, v57
    v_exp_f32 v58, v58
    v_exp_f32 v59, v59
    v_exp_f32 v60, v60
    v_exp_f32 v61, v61
    v_exp_f32 v62, v62
    v_exp_f32 v63, v63
    v_cvt_pk_bf16_f32 v64, v48, v49
    v_cvt_pk_bf16_f32 v65, v50, v51
    v_cvt_pk_bf16_f32 v66, v52, v53
    v_cvt_pk_bf16_f32 v67, v54, v55
    v_cvt_pk_bf16_f32 v68, v56, v57
    v_cvt_pk_bf16_f32 v69, v58, v59
    v_cvt_pk_bf16_f32 v70, v60, v61
    v_cvt_pk_bf16_f32 v71, v62, v63
    v_mfma_f32_32x32x16_bf16 v[80:95], v[40:43], v[64:67], v[80:95]
    s_nop 0
    v_mfma_f32_32x32x16_bf16 v[80:95], v[44:47], v[68:71], v[80:95]
    v_smfmac_f32_16x16x64_bf16 v[96:99], v[116:119], v[64:71], v120
    s_nop 15
    s_add_u32 s10, s10, 4096
    s_cmp_lt_u32 s10, 262144
    s_cbranch_scc1 L_slow2
    v_add_f32 v96, v96, v97
L_rx_155:
    s_nop 4
    s_branch L_ret_156
L_rare_168:
    v_mov_b32 v105, 1
    ds_write_b32 v104, v105
    s_waitcnt lgkmcnt(0)
L_rx_169:
    s_nop 4
    s_branch L_ret_170
L_rare_171:
    s_mov_b32 s99, 20000
L_redo_174:
    s_waitcnt vmcnt(0) lgkmcnt(0)
    s_nop 15
    s_barrier
    s_lshl_b32 s13, s5, 14
    s_sub_u32 s13, s13, 0x4000
    s_add_u32 m0, s98, 0
    s_add_u32 s13, s13, 0x4000
    s_and_b32 s13, s13, 0x1ffff
    buffer_load_dwordx4 v125, s[84:87], s13 offen offset:0 sc1 lds
    buffer_load_dwordx4 v125, s[84:87], s13 offen offset:1024 sc1 lds
    s_add_u32 m0, s98, 16384
    s_add_u32 s13, s13, 0x4000
    s_and_b32 s13, s13, 0x1ffff
    buffer_load_dwordx4 v125, s[84:87], s13 offen offset:0 sc1 lds
    buffer_load_dwordx4 v125, s[84:87], s13 offen offset:1024 sc1 lds
    s_add_u32 m0, s98, 32768
    s_add_u32 s13, s13, 0x4000
    s_and_b32 s13, s13, 0x1ffff
    buffer_load_dwordx4 v125, s[84:87], s13 offen offset:0 sc1 lds
    buffer_load_dwordx4 v125, s[84:87], s13 offen offset:1024 sc1 lds
    s_add_u32 m0, s98, 49152
    s_add_u32 s13, s13, 0x4000
    s_and_b32 s13, s13, 0x1ffff
    buffer_load_dwordx4 v125, s[84:87], s13 offen offset:0 sc1 lds
    buffer_load_dwordx4 v125, s[84:87], s13 offen offset:1024 sc1 lds
    s_add_u32 m0, s98, 65536
    s_add_u32 s13, s13, 0x4000
    s_and_b32 s13, s13, 0x1ffff
    buffer_load_dwordx4 v125, s[84:87], s13 offen offset:0 sc1 lds
    buffer_load_dwordx4 v125, s[84:87], s13 offen offset:1024 sc1 lds
    s_add_u32 m0, s98, 81920
    s_add_u32 s13, s13, 0x4000
    s_and_b32 s13, s13, 0x1ffff
    buffer_load_dwordx4 v125, s[84:87], s13 offen offset:0 sc1 lds
    buffer_load_dwordx4 v125, s[84:87], s13 offen offset:1024 sc1 lds
    s_add_u32 m0, s98, 98304
    s_add_u32 s13, s13, 0x4000
    s_and_b32 s13, s13, 0x1ffff
    buffer_load_dwordx4 v125, s[84:87], s13 offen offset:0 sc1 lds
    buffer_load_dwordx4 v125, s[84:87], s13 offen offset:1024 sc1 lds
    s_add_u32 m0, s98, 114688
    s_add_u32 s13, s13, 0x4000
    s_and_b32 s13, s13, 0x1ffff
    buffer_load_dwordx4 v125, s[84:87], s13 offen offset:0 sc1 lds
    buffer_load_dwordx4 v125, s[84:87], s13 offen offset:1024 sc1 lds
    v_mov_b32 v121, 0
    s_waitcnt vmcnt(0)
    s_barrier
    ds_read_b128 v[48:51], v116 offset:0
    ds_read_b128 v[52:55], v116 offset:4096
    ds_read_b128 v[56:59], v116 offset:8192
    ds_read_b128 v[60:63], v116 offset:12288
    ds_read_b128 v[64:67], v118 offset:0
    ds_read_b128 v[68:71], v118 offset:4096
    ds_read_b128 v[72:75], v118 offset:8192
    ds_read_b128 v[76:79], v118 offset:12288
    s_waitcnt lgkmcnt(0)
    v_mfma_f32_32x32x16_bf16 v[16:31], v[128:131], v[48:51], 0
    v_max3_u32 v121, v121, v48, v50
    v_mfma_f32_32x32x16_bf16 v[16:31], v[132:135], v[52:55], v[16:31]
    v_max3_u32 v121, v121, v52, v54
    v_mfma_f32_32x32x16_bf16 v[16:31], v[136:139], v[56:59], v[16:31]
    v_max3_u32 v121, v121, v56, v58
    v_mfma_f32_32x32x16_bf16 v[16:31], v[140:143], v[60:63], v[16:31]
    v_max3_u32 v121, v121, v60, v62
    v_mfma_f32_32x32x16_bf16 v[32:47], v[128:131], v[64:67], 0
    v_max3_u32 v121, v121, v64, v66
    v_mfma_f32_32x32x16_bf16 v[32:47], v[132:135], v[68:71], v[32:47]
    v_max3_u32 v121, v121, v68, v70
    v_mfma_f32_32x32x16_bf16 v[32:47], v[136:139], v[72:75], v[32:47]
    v_max3_u32 v121, v121, v72, v74
    v_mfma_f32_32x32x16_bf16 v[32:47], v[140:143], v[76:79], v[32:47]
    v_max3_u32 v121, v121, v76, v78
    ds_read_b128 v[48:51], v116 offset:16384
    ds_read_b128 v[52:55], v116 offset:20480
    ds_read_b128 v[56:59], v116 offset:24576
    ds_read_b128 v[60:63], v116 offset:28672
    ds_read_b128 v[64:67], v118 offset:16384
    ds_read_b128 v[68:71], v118 offset:20480
    ds_read_b128 v[72:75], v118 offset:24576
    ds_read_b128 v[76:79], v118 offset:28672
    s_waitcnt lgkmcnt(0)
    v_mfma_f32_32x32x16_bf16 v[16:31], v[144:147], v[48:51], v[16:31]
    v_max3_u32 v121, v121, v48, v50
    v_mfma_f32_32x32x16_bf16 v[16:31], v[148:151], v[52:55], v[16:31]
    v_max3_u32 v121, v121, v52, v54
    v_mfma_f32_32x32x16_bf16 v[16:31], v[152:155], v[56:59], v[16:31]
    v_max3_u32 v121, v121, v56, v58
    v_mfma_f32_32x32x16_bf16 v[16:31], v[156:159], v[60:63], v[16:31]
    v_max3_u32 v121, v121, v60, v62
    v_mfma_f32_32x32x16_bf16 v[32:47], v[144:147], v[64:67], v[32:47]
    v_max3_u32 v121, v121, v64, v66
    v_mfma_f32_32x32x16_bf16 v[32:47], v[148:151], v[68:71], v[32:47]
    v_max3_u32 v121, v121, v68, v70
    v_mfma_f32_32x32x16_bf16 v[32:47], v[152:155], v[72:75], v[32:47]
    v_max3_u32 v121, v121, v72, v74
    v_mfma_f32_32x32x16_bf16 v[32:47], v[156:159], v[76:79], v[32:47]
    v_max3_u32 v121, v121, v76, v78
    ds_read_b128 v[48:51], v116 offset:32768
    ds_read_b128 v[52:55], v116 offset:36864
    ds_read_b128 v[56:59], v116 offset:40960
    ds_read_b128 v[60:63], v116 offset:45056
    ds_read_b128 v[64:67], v118 offset:32768
    ds_read_b128 v[68:71], v118 offset:36864
    ds_read_b128 v[72:75], v118 offset:40960
    ds_read_b128 v[76:79], v118 offset:45056
    s_waitcnt lgkmcnt(0)
    v_mfma_f32_32x32x16_bf16 v[16:31], v[160:163], v[48:51], v[16:31]
    v_max3_u32 v121, v121, v48, v50
    v_mfma_f32_32x32x16_bf16 v[16:31], v[164:167], v[52:55], v[16:31]
    v_max3_u32 v121, v121, v52, v54
    v_mfma_f32_32x32x16_bf16 v[16:31], v[168:171], v[56:59], v[16:31]
    v_max3_u32 v121, v121, v56, v58
    v_mfma_f32_32x32x16_bf16 v[16:31], v[172:175], v[60:63], v[16:31]
    v_max3_u32 v121, v121, v60, v62
    v_mfma_f32_32x32x16_bf16 v[32:47], v[160:163], v[64:67], v[32:47]
    v_max3_u32 v121, v121, v64, v66
    v_mfma_f32_32x32x16_bf16 v[32:47], v[164:167], v[68:71], v[32:47]
    v_max3_u32 v121, v121, v68, v70
    v_mfma_f32_32x32x16_bf16 v[32:47], v[168:171], v[72:75], v[32:47]
    v_max3_u32 v121, v121, v72, v74
    v_mfma_f32_32x32x16_bf16 v[32:47], v[172:175], v[76:79], v[32:47]
    v_max3_u32 v121, v121, v76, v78
    ds_read_b128 v[48:51], v116 offset:49152
    ds_read_b128 v[52:55], v116 offset:53248
    ds_read_b128 v[56:59], v116 offset:57344
    ds_read_b128 v[60:63], v116 offset:61440
    ds_read_b128 v[64:67], v118 offset:49152
    ds_read_b128 v[68:71], v118 offset:53248
    ds_read_b128 v[72:75], v118 offset:57344
    ds_read_b128 v[76:79], v118 offset:61440
    s_waitcnt lgkmcnt(0)
    v_mfma_f32_32x32x16_bf16 v[16:31], v[176:179], v[48:51], v[16:31]
    v_max3_u32 v121, v121, v48, v50
    v_mfma_f32_32x32x16_bf16 v[16:31], v[180:183], v[52:55], v[16:31]
    v_max3_u32 v121, v121, v52, v54
    v_mfma_f32_32x32x16_bf16 v[16:31], v[184:187], v[56:59], v[16:31]
    v_max3_u32 v121, v121, v56, v58
    v_mfma_f32_32x32x16_bf16 v[16:31], v[188:191], v[60:63], v[16:31]
    v_max3_u32 v121, v121, v60, v62
    v_mfma_f32_32x32x16_bf16 v[32:47], v[176:179], v[64:67], v[32:47]
    v_max3_u32 v121, v121, v64, v66
    v_mfma_f32_32x32x16_bf16 v[32:47], v[180:183], v[68:71], v[32:47]
    v_max3_u32 v121, v121, v68, v70
    v_mfma_f32_32x32x16_bf16 v[32:47], v[184:187], v[72:75], v[32:47]
    v_max3_u32 v121, v121, v72, v74
    v_mfma_f32_32x32x16_bf16 v[32:47], v[188:191], v[76:79], v[32:47]
    v_max3_u32 v121, v121, v76, v78
    ds_read_b128 v[48:51], v117 offset:0
    ds_read_b128 v[52:55], v117 offset:4096
    ds_read_b128 v[56:59], v117 offset:8192
    ds_read_b128 v[60:63], v117 offset:12288
    ds_read_b128 v[64:67], v119 offset:0
    ds_read_b128 v[68:71], v119 offset:4096
    ds_read_b128 v[72:75], v119 offset:8192
    ds_read_b128 v[76:79], v119 offset:12288
    s_waitcnt lgkmcnt(0)
    v_mfma_f32_32x32x16_bf16 v[16:31], v[192:195], v[48:51], v[16:31]
    v_max3_u32 v121, v121, v48, v50
    v_mfma_f32_32x32x16_bf16 v[16:31], v[196:199], v[52:55], v[16:31]
    v_max3_u32 v121, v121, v52, v54
    v_mfma_f32_32x32x16_bf16 v[16:31], v[200:203], v[56:59], v[16:31]
    v_max3_u32 v121, v121, v56, v58
    v_mfma_f32_32x32x16_bf16 v[16:31], v[204:207], v[60:63], v[16:31]
    v_max3_u32 v121, v121, v60, v62
    v_mfma_f32_32x32x16_bf16 v[32:47], v[192:195], v[64:67], v[32:47]
    v_max3_u32 v121, v121, v64, v66
    v_mfma_f32_32x32x16_bf16 v[32:47], v[196:199], v[68:71], v[32:47]
    v_max3_u32 v121, v121, v68, v70
    v_mfma_f32_32x32x16_bf16 v[32:47], v[200:203], v[72:75], v[32:47]
    v_max3_u32 v121, v121, v72, v74
    v_mfma_f32_32x32x16_bf16 v[32:47], v[204:207], v[76:79], v[32:47]
    v_max3_u32 v121, v121, v76, v78
    ds_read_b128 v[48:51], v117 offset:16384
    ds_read_b128 v[52:55], v117 offset:20480
    ds_read_b128 v[56:59], v117 offset:24576
    ds_read_b128 v[60:63], v117 offset:28672
    ds_read_b128 v[64:67], v119 offset:16384
    ds_read_b128 v[68:71], v119 offset:20480
    ds_read_b128 v[72:75], v119 offset:24576
    ds_read_b128 v[76:79], v119 offset:28672
    s_waitcnt lgkmcnt(0)
    v_mfma_f32_32x32x16_bf16 v[16:31], v[208:211], v[48:51], v[16:31]
    v_max3_u32 v121, v121, v48, v50
    v_mfma_f32_32x32x16_bf16 v[16:31], v[212:215], v[52:55], v[16:31]
    v_max3_u32 v121, v121, v52, v54
    v_mfma_f32_32x32x16_bf16 v[16:31], v[216:219], v[56:59], v[16:31]
    v_max3_u32 v121, v121, v56, v58
    v_mfma_f32_32x32x16_bf16 v[16:31], v[220:223], v[60:63], v[16:31]
    v_max3_u32 v121, v121, v60, v62
    v_mfma_f32_32x32x16_bf16 v[32:47], v[208:211], v[64:67], v[32:47]
    v_max3_u32 v121, v121, v64, v66
    v_mfma_f32_32x32x16_bf16 v[32:47], v[212:215], v[68:71], v[32:47]
    v_max3_u32 v121, v121, v68, v70
    v_mfma_f32_32x32x16_bf16 v[32:47], v[216:219], v[72:75], v[32:47]
    v_max3_u32 v121, v121, v72, v74
    v_mfma_f32_32x32x16_bf16 v[32:47], v[220:223], v[76:79], v[32:47]
    v_max3_u32 v121, v121, v76, v78
    ds_read_b128 v[48:51], v117 offset:32768
    ds_read_b128 v[52:55], v117 offset:36864
    ds_read_b128 v[56:59], v117 offset:40960
    ds_read_b128 v[60:63], v117 offset:45056
    ds_read_b128 v[64:67], v119 offset:32768
    ds_read_b128 v[68:71], v119 offset:36864
    ds_read_b128 v[72:75], v119 offset:40960
    ds_read_b128 v[76:79], v119 offset:45056
    s_waitcnt lgkmcnt(0)
    v_mfma_f32_32x32x16_bf16 v[16:31], v[224:227], v[48:51], v[16:31]
    v_max3_u32 v121, v121, v48, v50
    v_mfma_f32_32x32x16_bf16 v[16:31], v[228:231], v[52:55], v[16:31]
    v_max3_u32 v121, v121, v52, v54
    v_mfma_f32_32x32x16_bf16 v[16:31], v[232:235], v[56:59], v[16:31]
    v_max3_u32 v121, v121, v56, v58
    v_mfma_f32_32x32x16_bf16 v[16:31], v[236:239], v[60:63], v[16:31]
    v_max3_u32 v121, v121, v60, v62
    v_mfma_f32_32x32x16_bf16 v[32:47], v[224:227], v[64:67], v[32:47]
    v_max3_u32 v121, v121, v64, v66
    v_mfma_f32_32x32x16_bf16 v[32:47], v[228:231], v[68:71], v[32:47]
    v_max3_u32 v121, v121, v68, v70
    v_mfma_f32_32x32x16_bf16 v[32:47], v[232:235], v[72:75], v[32:47]
    v_max3_u32 v121, v121, v72, v74
    v_mfma_f32_32x32x16_bf16 v[32:47], v[236:239], v[76:79], v[32:47]
    v_max3_u32 v121, v121, v76, v78
    ds_read_b128 v[48:51], v117 offset:49152
    ds_read_b128 v[52:55], v117 offset:53248
    ds_read_b128 v[56:59], v117 offset:57344
    ds_read_b128 v[60:63], v117 offset:61440
    ds_read_b128 v[64:67], v119 offset:49152
    ds_read_b128 v[68:71], v119 offset:53248
    ds_read_b128 v[72:75], v119 offset:57344
    ds_read_b128 v[76:79], v119 offset:61440
    s_waitcnt lgkmcnt(0)
    v_mfma_f32_32x32x16_bf16 v[16:31], v[240:243], v[48:51], v[16:31]
    v_max3_u32 v121, v121, v48, v50
    v_mfma_f32_32x32x16_bf16 v[16:31], v[244:247], v[52:55], v[16:31]
    v_max3_u32 v121, v121, v52, v54
    v_mfma_f32_32x32x16_bf16 v[16:31], v[248:251], v[56:59], v[16:31]
    v_max3_u32 v121, v121, v56, v58
    v_mfma_f32_32x32x16_bf16 v[16:31], v[252:255], v[60:63], v[16:31]
    v_max3_u32 v121, v121, v60, v62
    v_mfma_f32_32x32x16_bf16 v[32:47], v[240:243], v[64:67], v[32:47]
    v_max3_u32 v121, v121, v64, v66
    v_mfma_f32_32x32x16_bf16 v[32:47], v[244:247], v[68:71], v[32:47]
    v_max3_u32 v121, v121, v68, v70
    v_mfma_f32_32x32x16_bf16 v[32:47], v[248:251], v[72:75], v[32:47]
    v_max3_u32 v121, v121, v72, v74
    v_mfma_f32_32x32x16_bf16 v[32:47], v[252:255], v[76:79], v[32:47]
    v_max3_u32 v121, v121, v76, v78
    s_barrier
    ds_write_b32 v104, v104
    s_nop 0
    ds_write_b128 v123, v[16:19] offset:0
    ds_write_b128 v123, v[20:23] offset:1024
    ds_write_b128 v123, v[24:27] offset:2048
    ds_write_b128 v123, v[28:31] offset:3072
    s_waitcnt lgkmcnt(0)
    s_barrier
    v_cmp_eq_u32 vcc, -1, v121
    v_mov_b32 v105, 1
    s_mov_b64 exec, vcc
    ds_write_b32 v104, v105
    s_mov_b64 exec, -1
    s_waitcnt lgkmcnt(0)
    s_barrier
    ds_read_b32 v105, v104
    ds_read_b128 v[16:19], v124 offset:0
    ds_read_b128 v[20:23], v124 offset:1024
    ds_read_b128 v[24:27], v124 offset:2048
    ds_read_b128 v[28:31], v124 offset:3072
    s_waitcnt lgkmcnt(0)
    v_cmp_ne_u32 vcc, 0, v105
    s_sub_u32 s99, s99, 1
    s_cbranch_scc1 L_rx_172
    s_cbranch_vccnz L_redo_174
L_rx_172:
    s_nop 4
    s_branch L_ret_173
.section .rodata,"a"
.p2align 6
.amdhsa_kernel recurrent_scan__grouped_kv_mqa__moe_arch_mod__prompt_kernel
  .amdhsa_next_free_vgpr 256
  .amdhsa_next_free_sgpr 102
  .amdhsa_accum_offset 256
  .amdhsa_group_segment_fixed_size 0
  .amdhsa_kernarg_size 104
  .amdhsa_user_sgpr_count 2
  .amdhsa_user_sgpr_kernarg_segment_ptr 1
  .amdhsa_system_sgpr_workgroup_id_x 1
.end_amdhsa_kernel
```
